```python
import torch

def _softmax(x, axis=-1):
    return torch.softmax(x, dim=axis)

def _gelu(x):
    return torch.nn.functional.gelu(x, approximate='tanh')

def _silu(x):
    return torch.nn.functional.silu(x)

def _sigmoid(x):
    return torch.sigmoid(x)

def _layernorm(x, axis=-1, eps=1e-05):
    m = x.mean(dim=axis, keepdim=True)
    v = x.var(dim=axis, keepdim=True, unbiased=False)
    return (x - m) / torch.sqrt(v + eps)

def _scatter_add(tgt, idx, src, axis=0):
    return tgt.clone().index_add_(axis, idx, src)

def _segment_sum(src, seg, n):
    out = torch.zeros((n,) + src.shape[1:], dtype=src.dtype)
    return out.index_add_(0, seg, src)

def _pad(x, pw):
    flat = tuple((v for pair in reversed(pw) for v in pair))
    return torch.nn.functional.pad(x, flat)
kernel_name = 'adaLN_cond__ssm_conv_h3__glu_gated_geglu__prompt'

def setup_inputs():

    _w = lambda a: (lambda t: t.to(torch.bfloat16) if t.is_floating_point() else t)(torch.as_tensor(a))

    def _A_setup():
        B, S, D = (1, 2048, 512)
        ks = 4
        return {'q': _w((lambda *s: torch.randn(*s, dtype=torch.bfloat16) * 0.05)(B, S, D)), 'k': _w((lambda *s: torch.randn(*s, dtype=torch.bfloat16) * 1.6)(B, S, D)), 'v': _w((lambda *s: torch.randn(*s, dtype=torch.bfloat16) * 1.6)(B, S, D)), 'shift_k': _w((lambda *s: torch.randn(*s, dtype=torch.bfloat16) * 1.6)(D, ks) * 0.5), 'ssm_k': _w((lambda *s: torch.randn(*s, dtype=torch.bfloat16) * 1.6)(D, S) * (1.0 / S ** 0.5)), 'ssm_D': _w((lambda *s: torch.randn(*s, dtype=torch.bfloat16) * 1.6)(D))}
    _A_in = _A_setup()

    def _B_setup():
        B, S, Dm, Df = (1, 2048, 512, 1792)
        return {'x': _w((lambda *s: torch.randn(*s, dtype=torch.bfloat16) * 0.05)(B, S, Dm)), 'w_gate': _w((lambda *s: torch.randn(*s, dtype=torch.bfloat16) * 3.2)(Dm, Df) * Dm ** (-0.5)), 'w_up': _w((lambda *s: torch.randn(*s, dtype=torch.bfloat16) * 3.2)(Dm, Df) * Dm ** (-0.5)), 'w_down': _w((lambda *s: torch.randn(*s, dtype=torch.bfloat16) * 3.2)(Df, Dm) * Df ** (-0.5))}
    _B_in = _B_setup()
    return {'A_q': _A_in['q'], 'A_k': _A_in['k'], 'A_v': _A_in['v'], 'A_shift_k': _A_in['shift_k'], 'A_ssm_k': _A_in['ssm_k'], 'A_ssm_D': _A_in['ssm_D'], 'B_x': _B_in['x'], 'B_w_gate': _B_in['w_gate'], 'B_w_up': _B_in['w_up'], 'B_w_down': _B_in['w_down'], 'c': _w((lambda *s: torch.randn(*s, dtype=torch.bfloat16) * 0.1)(1, 512) * 8.0), 'w_mod': _w((lambda *s: torch.randn(*s, dtype=torch.bfloat16) * 0.1)(512, 6 * 512) * 512 ** (-0.5) * 8.0)}

def reference(A_q, A_k, A_v, A_shift_k, A_ssm_k, A_ssm_D, B_x, B_w_gate, B_w_up, B_w_down, c, w_mod):

    def _A_ref(q, k, v, shift_k, ssm_k, ssm_D):
        B, S, D = q.shape
        ks = shift_k.shape[-1]
        k_pad = _pad(k, ((0, 0), (ks - 1, 0), (0, 0)))
        k_shift = torch.zeros_like(k)
        for t in range(ks):
            k_shift = k_shift + k_pad[:, t:t + S, :] * shift_k[:, ks - 1 - t][None, None, :]
        kv = k_shift * v
        L = 2 * S
        kv_pad = _pad(kv, ((0, 0), (0, S), (0, 0)))
        kf_pad = _pad(ssm_k, ((0, 0), (0, S)))
        kv_f = (lambda x, axes=(-2, -1): torch.fft.rfft2(x.float(), dim=axes))(kv_pad[:, None, :, :], axes=(1, 2))
        kf_f = (lambda x, axes=(-2, -1): torch.fft.rfft2(x.float(), dim=axes))(kf_pad[:, None, :], axes=(1, 2))
        kf_f = (lambda x, *d: x.permute(*d))(kf_f, 1, 2, 0)
        y_f = kv_f * kf_f[None, :, :, :]
        y = (lambda x, s, axes=(-2, -1): torch.fft.irfft2(x, s=s, dim=axes).to(torch.bfloat16))(y_f, (1, L), axes=(1, 2))[:, 0, :S, :]
        y = y + kv * ssm_D[None, None, :]
        return q * y

    def _B_ref(x, w_gate, w_up, w_down):
        g = torch.einsum('bsd,df->bsf', x, w_gate)
        u = torch.einsum('bsd,df->bsf', x, w_up)
        h = _gelu(g) * u
        return torch.einsum('bsf,fd->bsd', h, w_down)
    x = A_q
    mod = (_silu(c) @ w_mod).reshape(c.shape[0], 6, 1, -1)
    sa, ca, ga, sb, cb, gb = (mod[:, 0].clone(), mod[:, 1].clone(), mod[:, 2].clone(), mod[:, 3].clone(), mod[:, 4].clone(), mod[:, 5].clone())
    h = _layernorm(x, axis=-1) * (1 + ca) + sa
    x = x + ga * _A_ref(h, A_k, A_v, A_shift_k, A_ssm_k, A_ssm_D)
    h = _layernorm(x, axis=-1) * (1 + cb) + sb
    x = x + gb * _B_ref(h, B_w_gate, B_w_up, B_w_down)
    return x
```

```asm
; @launch grid=(256,1,1) block=(512,1,1) lds=163840
.amdgcn_target "amdgcn-amd-amdhsa--gfx950"
.text
.globl adaLN_cond__ssm_conv_h3__glu_gated_geglu__prompt_kernel
.p2align 8
.type adaLN_cond__ssm_conv_h3__glu_gated_geglu__prompt_kernel,@function
adaLN_cond__ssm_conv_h3__glu_gated_geglu__prompt_kernel:
    s_load_dwordx16 s[4:19], s[0:1], 0
    s_load_dwordx8 s[20:27], s[0:1], 64
    s_load_dwordx4 s[28:31], s[0:1], 96
    s_load_dwordx2 s[32:33], s[0:1], 112
    s_cmp_ge_u32 s2, 256
    s_cbranch_scc1 L_exit
    s_getpc_b64 s[78:79]
L_pc:
    s_lshr_b32 s35, s2, 3
    v_lshl_add_u32 v13, v0, 5, s35
    v_min_u32 v13, (L_last-L_pc)>>7, v13
    v_lshlrev_b32 v13, 7, v13
    v_lshrrev_b32 v8, 6, v0
    global_load_dword v82, v13, s[78:79]
    v_and_b32 v1, 63, v0
    s_and_b32 s34, s2, 7
    v_readfirstlane_b32 s36, v8
    v_lshrrev_b32 v10, 3, v1
    v_and_b32 v11, 7, v1
    v_lshlrev_b32 v12, 10, v10
    v_lshl_add_u32 v12, v11, 4, v12
    s_lshl_b32 s37, s34, 5
    s_add_u32 s37, s37, s35
    s_lshl_b32 s77, s34, 7
    s_lshl_b32 s75, s35, 3
    s_add_u32 s75, s75, s36
    s_lshl_b32 s75, s75, 13
    s_add_u32 s75, s75, s77
    s_mul_i32 s76, s36, 1040
    s_mov_b32 s46, 2097152
    s_mov_b32 s47, 0x20000
    s_mov_b32 s50, 2097152
    s_mov_b32 s51, 0x20000
    s_mov_b32 s70, 2097152
    s_mov_b32 s71, 0x20000
    s_mov_b32 s66, 18874368
    s_mov_b32 s67, 0x20000
    s_getreg_b32 s41, hwreg(HW_REG_XCC_ID, 0, 4)
    s_add_u32 s41, s41, 1
    v_mov_b32 v8, s37
    v_mov_b32 v9, s41
    s_sub_u32 s72, s75, 8192
    v_add_u32 v24, s72, v12
    s_lshl_b32 s72, s34, 3
    s_add_u32 s72, s72, s36
    s_lshl_b32 s72, s72, 6
    v_lshl_add_u32 v13, v10, 3, s72
    s_lshl_b32 s74, s37, 13
    v_lshl_add_u32 v22, v0, 4, s74
    v_add_u32 v23, -4, v22
    s_lshl_b32 s72, s35, 5
    v_lshl_add_u32 v25, v10, 1, s72
    s_lshl_b32 s72, s36, 10
    s_add_u32 s72, s72, s77
    s_mul_i32 s73, s35, 98304
    s_add_u32 s72, s72, s73
    s_sub_u32 s72, s72, 2048
    v_mul_u32_u24 v26, 5120, v10
    v_add3_u32 v26, v26, v12, s72
    v_add_u32 v27, 49152, v26
    s_add_u32 s74, s74, 1048576
    s_mul_i32 s73, s37, 3072
    s_add_u32 s73, s73, 65536
    s_cmp_eq_u32 s36, 0
    s_cselect_b32 s74, s74, s73
    s_cselect_b32 s73, 63, 23
    v_min_u32 v28, s73, v1
    v_lshlrev_b32 v28, 7, v28
    s_lshl_b32 s72, s34, 3
    s_and_b32 s73, s35, 7
    s_add_u32 s72, s72, s73
    s_lshl_b32 s72, s72, 7
    s_lshr_b32 s73, s35, 3
    s_lshl_b32 s73, s73, 13
    s_add_u32 s72, s72, s73
    s_add_u32 s97, s72, 16384
    v_mov_b32 v29, 0
    s_add_u32 m0, s76, 1040
    s_lshl_b32 s72, s37, 2
    s_waitcnt lgkmcnt(0)
    s_mov_b64 s[44:45], s[6:7]
    s_mov_b64 s[48:49], s[8:9]
    buffer_load_dwordx4 v12, s[44:47], s75 offen nt lds
    s_add_u32 m0, s76, 9360
    s_mov_b64 s[68:69], s[12:13]
    buffer_load_dwordx4 v12, s[48:51], s75 offen nt lds
    s_mov_b64 s[64:65], s[32:33]
    global_load_dwordx2 v[30:31], v13, s[10:11]
    s_cmp_lg_u32 s36, 0
    s_cbranch_scc1 nw0_1
    s_mov_b32 m0, 0
    s_mov_b32 exec_lo, 0
    s_mov_b32 exec_hi, 0xffffff00
    buffer_load_dwordx4 v24, s[44:47], 0 offen lds
    s_mov_b64 exec, 1
    global_store_byte v8, v9, s[30:31]
    s_mov_b64 exec, -1
nw0_1:
    s_load_dword s38, s[32:33], 0
    s_load_dword s42, s[14:15], s72
    s_barrier
    buffer_load_dwordx4 v[16:19], v22, s[68:71], 0 offen
    buffer_load_dword v20, v23, s[68:71], 0 offen
    v_mov_b32 v32, 0
    v_mov_b32 v33, 0
    v_mov_b32 v34, 0
    v_mov_b32 v35, 0
    v_mov_b32 v36, 0
    v_mov_b32 v37, 0
    v_mov_b32 v38, 0
    v_mov_b32 v39, 0
    v_mov_b32 v40, 0
    v_mov_b32 v41, 0
    v_mov_b32 v42, 0
    v_mov_b32 v43, 0
    v_mov_b32 v44, 0
    v_mov_b32 v45, 0
    v_mov_b32 v46, 0
    v_mov_b32 v47, 0
    v_mov_b32 v48, 0
    v_mov_b32 v49, 0
    v_mov_b32 v50, 0
    s_cmp_lg_u32 s36, 1
    s_cbranch_scc1 nz_2
    v_lshrrev_b32 v8, 5, v1
    v_and_b32 v9, 31, v1
    v_mul_u32_u24 v8, 4608, v8
    v_lshl_add_u32 v8, v9, 4, v8
    v_add_u32 v8, 118784, v8
    ds_write_b128 v8, v[32:35]
    v_and_b32 v8, 1, v1
    v_bfe_u32 v9, v1, 1, 1
    v_lshlrev_b32 v8, 4, v8
    v_mul_u32_u24 v9, 4160, v9
    v_add_u32 v8, v8, v9
    v_bfe_u32 v9, v1, 2, 1
    v_mul_u32_u24 v9, 8320, v9
    v_add3_u32 v8, v8, v9, 0
    v_add_u32 v8, 131072, v8
    ds_write_b128 v8, v[32:35]
nz_2:
    s_mov_b64 s[52:53], s[18:19]
    s_mov_b32 s54, 1835008
    s_mov_b32 s55, 0x20000
    s_mov_b64 s[56:57], s[20:21]
    s_mov_b32 s58, 1835008
    s_mov_b32 s59, 0x20000
    s_mov_b64 s[60:61], s[22:23]
    s_mov_b32 s62, 1835008
    s_mov_b32 s63, 0x20000
    v_mov_b32 v135, 0
    v_mov_b32 v136, 0
    v_mov_b32 v137, 0
    v_mov_b32 v138, 0
    v_mov_b32 v139, 0
    v_mov_b32 v140, 0
    v_mov_b32 v141, 0
    v_mov_b32 v142, 0
    s_lshr_b32 s3, s35, 2
    s_add_u32 s3, s3, 4
    s_and_b32 s3, s3, 7
    s_lshl_b32 s3, s3, 7
    s_lshl_b32 s72, s34, 5
    v_and_b32 v14, 31, v1
    v_add_u32 v14, s72, v14
    s_lshl_b32 s72, s37, 3
    s_add_u32 s72, s72, s36
    s_lshl_b32 s72, s72, 10
    v_lshl_add_u32 v15, v1, 4, s72
    v_lshlrev_b32 v12, 12, v10
    v_lshlrev_b32 v9, 4, v11
    v_sub_u32 v12, v12, v9
    v_add_u32 v12, 112, v12
    s_lshl_b32 s72, s34, 3
    s_add_u32 s72, s72, s36
    s_lshl_b32 s72, s72, 15
    s_lshl_b32 s73, s35, 7
    s_sub_u32 s72, s72, s73
    s_add_u32 s75, s72, 1052544
    v_and_b32 v8, 255, v0
    v_lshrrev_b32 v9, 8, v0
    v_mul_u32_u24 v2, 8320, v9
    v_lshl_add_u32 v2, v8, 4, v2
    v_add_u32 v2, 131072, v2
    v_lshlrev_b32 v23, 4, v0
    v_lshl_add_u32 v5, v9, 9, v23
    v_add_u32 v5, 114688, v5
    v_bfe_u32 v8, v1, 1, 3
    v_lshrrev_b32 v6, 4, v1
    v_lshl_add_u32 v8, v6, 2, v8
    v_lshlrev_b32 v8, 2, v8
    v_and_b32 v9, 1, v1
    v_xor_b32 v9, 1, v9
    v_mul_u32_u24 v9, 4160, v9
    s_lshr_b32 s72, s36, 1
    s_mul_i32 s76, s72, 8320
    s_and_b32 s73, s36, 1
    s_lshl_b32 s73, s73, 8
    s_add_u32 s76, s76, s73
    s_add_u32 s76, s76, 131076
    v_add3_u32 v3, v8, v9, s76
    v_lshl_add_u32 v13, v11, 2, v6
    v_mul_u32_u24 v13, 3072, v13
    s_mul_i32 s72, s72, 4608
    s_add_u32 s72, s72, s73
    s_add_u32 s72, s72, 115168
    v_and_b32 v9, 15, v1
    v_lshl_add_u32 v7, v6, 4, s72
    v_lshlrev_b32 v8, 5, v9
    v_sub_u32 v7, v7, v8
    v_lshl_add_u32 v9, v6, 2, v9
    v_and_b32 v9, 15, v9
    v_lshl_add_u32 v9, v6, 4, v9
    s_lshl_b32 s72, s36, 13
    s_add_u32 s72, s72, 131072
    v_lshl_add_u32 v6, v9, 4, s72
    s_and_b32 s73, s36, 3
    s_lshl_b32 s73, s73, 3
    s_sub_u32 s73, 31, s73
    v_sub_u32 v4, s73, v10
    v_lshlrev_b32 v4, 2, v4
    v_and_b32 v9, 3, v1
    v_lshrrev_b32 v21, 2, v1
    v_lshl_add_u32 v21, v9, 2, v21
    v_and_b32 v21, 15, v21
    v_lshl_add_u32 v21, v9, 4, v21
    s_lshl_b32 s72, s36, 10
    s_add_u32 s72, s72, 131072
    v_lshl_add_u32 v21, v21, 4, s72
    s_lshl_b32 s72, s36, 9
    s_sub_u32 s72, 118776, s72
    v_lshlrev_b32 v22, 3, v1
    v_sub_u32 v22, s72, v22
    s_mul_i32 s72, s36, 261120
    s_lshl_b32 s73, s37, 10
    s_add_u32 s72, s72, s73
    s_add_u32 s11, s72, 3145728
    v_mov_b32 v68, -1
    v_mov_b32 v69, -1
    v_mov_b32 v70, -1
    v_mov_b32 v71, -1
    buffer_store_dwordx4 v[68:71], v23, s[64:67], s11 offen sc1
    v_lshrrev_b32 v9, 5, v1
    v_lshlrev_b32 v9, 10, v9
    v_lshl_add_u32 v64, v1, 4, v9
    s_mul_i32 s72, s37, 3072
    s_add_u32 s77, s72, 65536
    s_mul_i32 s72, s34, 98304
    s_lshl_b32 s73, s35, 4
    s_add_u32 s72, s72, s73
    s_lshl_b32 s73, s36, 9
    s_add_u32 s72, s72, s73
    s_add_u32 s76, s72, 64512
    s_lshl_b32 s72, s36, 4
    v_mul_u32_u24 v8, 1040, v11
    v_lshl_add_u32 v8, v10, 1, v8
    v_add_u32 v8, s72, v8
    s_cmp_ge_u32 s36, 2
    s_cbranch_scc1 wm_3
    buffer_load_dword v80, v28, s[64:67], s74 offen sc1
    buffer_load_dword v81, v29, s[64:67], s97 offen sc1
    buffer_load_dword v83, v29, s[64:67], s97 offen sc1
    buffer_load_dword v84, v29, s[64:67], s97 offen sc1
    s_branch wj_4
wm_3:
    global_load_ushort v80, v25, s[24:25]
    global_load_ushort v81, v25, s[24:25] offset:16
    global_load_dwordx4 v[72:75], v26, s[26:27] nt
    global_load_dwordx4 v[76:79], v27, s[26:27] nt
wj_4:
    global_load_ubyte v65, v14, s[30:31] sc1
    s_waitcnt vmcnt(8) lgkmcnt(0)
    s_barrier
    ds_read_u16_d16_hi v32, v8 offset:640
    ds_read_u16_d16_hi v33, v8 offset:768
    ds_read_u16_d16_hi v34, v8 offset:896
    ds_read_u16_d16_hi v35, v8 offset:1040
    ds_read_u16_d16_hi v36, v8 offset:1168
    ds_read_u16_d16_hi v37, v8 offset:1296
    ds_read_u16_d16_hi v38, v8 offset:1424
    ds_read_u16_d16_hi v39, v8 offset:1552
    ds_read_u16_d16_hi v40, v8 offset:1680
    ds_read_u16_d16_hi v41, v8 offset:1808
    ds_read_u16_d16_hi v42, v8 offset:1936
    v_lshlrev_b32 v28, 16, v30
    v_and_b32 v29, 0xffff0000, v30
    v_lshlrev_b32 v30, 16, v31
    v_and_b32 v31, 0xffff0000, v31
    s_mul_i32 s38, s38, 0x9E3779B1
    s_add_u32 s38, s38, 0x7F4A7C15
    s_mul_i32 s39, s38, 0x85EBCA6B
    s_xor_b32 s39, s39, 0x5BD1E995
    s_and_b32 s43, s42, 0xffff0000
    s_lshl_b32 s42, s42, 16
    s_waitcnt lgkmcnt(7)
    ds_read_u16_d16_hi v43, v8 offset:9360
    ds_read_u16_d16_hi v44, v8 offset:9488
    ds_read_u16_d16_hi v45, v8 offset:9616
    ds_read_u16_d16_hi v46, v8 offset:9744
    ds_read_u16_d16_hi v47, v8 offset:9872
    ds_read_u16_d16_hi v48, v8 offset:10000
    ds_read_u16_d16_hi v49, v8 offset:10128
    ds_read_u16_d16_hi v50, v8 offset:10256
    s_waitcnt lgkmcnt(8)
    v_mul_f32 v52, v28, v35
    v_mul_f32 v53, v28, v36
    v_mul_f32 v54, v28, v37
    v_mul_f32 v55, v28, v38
    v_mul_f32 v56, v28, v39
    v_mul_f32 v57, v28, v40
    v_mul_f32 v58, v28, v41
    v_mul_f32 v59, v28, v42
    v_fmac_f32 v52, v29, v34
    v_fmac_f32 v53, v29, v35
    v_fmac_f32 v54, v29, v36
    v_fmac_f32 v55, v29, v37
    v_fmac_f32 v56, v29, v38
    v_fmac_f32 v57, v29, v39
    v_fmac_f32 v58, v29, v40
    v_fmac_f32 v59, v29, v41
    v_fmac_f32 v52, v30, v33
    v_fmac_f32 v53, v30, v34
    v_fmac_f32 v54, v30, v35
    v_fmac_f32 v55, v30, v36
    v_fmac_f32 v56, v30, v37
    v_fmac_f32 v57, v30, v38
    v_fmac_f32 v58, v30, v39
    v_fmac_f32 v59, v30, v40
    v_fmac_f32 v52, v31, v32
    v_fmac_f32 v53, v31, v33
    v_fmac_f32 v54, v31, v34
    v_fmac_f32 v55, v31, v35
    v_fmac_f32 v56, v31, v36
    v_fmac_f32 v57, v31, v37
    v_fmac_f32 v58, v31, v38
    v_fmac_f32 v59, v31, v39
    s_waitcnt lgkmcnt(0)
    v_mul_f32 v52, v52, v43
    v_mul_f32 v53, v53, v44
    v_mul_f32 v54, v54, v45
    v_mul_f32 v55, v55, v46
    v_mul_f32 v56, v56, v47
    v_mul_f32 v57, v57, v48
    v_mul_f32 v58, v58, v49
    v_mul_f32 v59, v59, v50
    v_cvt_pk_bf16_f32 v60, v59, v58
    v_cvt_pk_bf16_f32 v61, v57, v56
    v_cvt_pk_bf16_f32 v62, v55, v54
    v_cvt_pk_bf16_f32 v63, v53, v52
    v_and_b32 v8, 255, v0
    v_cmp_ne_u32 vcc, 0, v8
    s_waitcnt vmcnt(6)
    v_alignbit_b32 v25, v17, v16, 16
    v_alignbit_b32 v26, v18, v17, 16
    v_cndmask_b32 v20, 0, v20, vcc
    v_alignbit_b32 v27, v19, v18, 16
    v_alignbit_b32 v24, v16, v20, 16
    ds_write_b128 v2, v[16:19] offset:32
    ds_write_b128 v2, v[24:27] offset:4192
    s_waitcnt lgkmcnt(0)
    s_barrier
    s_cmp_ge_u32 s36, 4
    s_cbranch_scc1 na_5
    ds_read2_b32 v[128:129], v3 offset0:0 offset1:1
    ds_read2_b32 v[130:131], v3 offset0:2 offset1:3
    ds_read2_b32 v[160:161], v3 offset0:16 offset1:17
    ds_read2_b32 v[162:163], v3 offset0:18 offset1:19
    ds_read2_b32 v[192:193], v3 offset0:32 offset1:33
    ds_read2_b32 v[194:195], v3 offset0:34 offset1:35
    ds_read2_b32 v[224:225], v3 offset0:48 offset1:49
    ds_read2_b32 v[226:227], v3 offset0:50 offset1:51
    ds_read2_b32 v[132:133], v3 offset0:128 offset1:129
    ds_read2_b32 v[134:135], v3 offset0:130 offset1:131
    ds_read2_b32 v[164:165], v3 offset0:144 offset1:145
    ds_read2_b32 v[166:167], v3 offset0:146 offset1:147
    ds_read2_b32 v[196:197], v3 offset0:160 offset1:161
    ds_read2_b32 v[198:199], v3 offset0:162 offset1:163
    ds_read2_b32 v[228:229], v3 offset0:176 offset1:177
    ds_read2_b32 v[230:231], v3 offset0:178 offset1:179
    v_add_u32 v3, 1024, v3
    ds_read2_b32 v[136:137], v3 offset0:0 offset1:1
    ds_read2_b32 v[138:139], v3 offset0:2 offset1:3
    ds_read2_b32 v[168:169], v3 offset0:16 offset1:17
    ds_read2_b32 v[170:171], v3 offset0:18 offset1:19
    ds_read2_b32 v[200:201], v3 offset0:32 offset1:33
    ds_read2_b32 v[202:203], v3 offset0:34 offset1:35
    ds_read2_b32 v[232:233], v3 offset0:48 offset1:49
    ds_read2_b32 v[234:235], v3 offset0:50 offset1:51
    ds_read2_b32 v[140:141], v3 offset0:128 offset1:129
    ds_read2_b32 v[142:143], v3 offset0:130 offset1:131
    ds_read2_b32 v[172:173], v3 offset0:144 offset1:145
    ds_read2_b32 v[174:175], v3 offset0:146 offset1:147
    ds_read2_b32 v[204:205], v3 offset0:160 offset1:161
    ds_read2_b32 v[206:207], v3 offset0:162 offset1:163
    ds_read2_b32 v[236:237], v3 offset0:176 offset1:177
    ds_read2_b32 v[238:239], v3 offset0:178 offset1:179
    v_add_u32 v3, 1024, v3
na_5:
    s_mov_b32 s40, 0
    s_mov_b32 s74, 0
    s_waitcnt vmcnt(0)
id_6:
    v_cmp_ne_u32 vcc, s41, v65
    s_nop 0
    s_cmp_eq_u64 vcc, 0
    s_cselect_b32 s40, 1, 0
    s_cbranch_scc1 iddone_7
    s_add_u32 s74, s74, 1
    s_cmp_ge_u32 s74, 6
    s_cbranch_scc1 iddone_7
    global_load_ubyte v65, v14, s[30:31] sc1
    s_waitcnt vmcnt(0)
    s_branch id_6
iddone_7:
    s_cmp_eq_u32 s40, 0
    s_cbranch_scc1 slow_8
    buffer_store_dwordx4 v[60:63], v12, s[64:67], s75 offen
    s_branch join_9
slow_8:
    buffer_store_dwordx4 v[60:63], v12, s[64:67], s75 offen sc1
join_9:
    s_cmp_ge_u32 s36, 4
    s_cbranch_scc1 na_10
    ds_read2_b32 v[144:145], v3 offset0:0 offset1:1
    ds_read2_b32 v[146:147], v3 offset0:2 offset1:3
    ds_read2_b32 v[176:177], v3 offset0:16 offset1:17
    ds_read2_b32 v[178:179], v3 offset0:18 offset1:19
    ds_read2_b32 v[208:209], v3 offset0:32 offset1:33
    ds_read2_b32 v[210:211], v3 offset0:34 offset1:35
    ds_read2_b32 v[240:241], v3 offset0:48 offset1:49
    ds_read2_b32 v[242:243], v3 offset0:50 offset1:51
    ds_read2_b32 v[148:149], v3 offset0:128 offset1:129
    ds_read2_b32 v[150:151], v3 offset0:130 offset1:131
    ds_read2_b32 v[180:181], v3 offset0:144 offset1:145
    ds_read2_b32 v[182:183], v3 offset0:146 offset1:147
    ds_read2_b32 v[212:213], v3 offset0:160 offset1:161
    ds_read2_b32 v[214:215], v3 offset0:162 offset1:163
    ds_read2_b32 v[244:245], v3 offset0:176 offset1:177
    ds_read2_b32 v[246:247], v3 offset0:178 offset1:179
    v_add_u32 v3, 1024, v3
na_10:
    s_cmp_lt_u32 s36, 2
    s_cbranch_scc1 nm_11
    v_lshlrev_b32 v80, 16, v80
    v_mul_f32 v82, 0xbfb8aa3b, v80
    v_lshlrev_b32 v81, 16, v81
    v_mul_f32 v83, 0xbfb8aa3b, v81
    v_exp_f32 v82, v82
    v_exp_f32 v83, v83
    v_add_f32 v82, 1.0, v82
    v_add_f32 v83, 1.0, v83
    v_rcp_f32 v82, v82
    v_rcp_f32 v83, v83
    v_mul_f32 v80, v80, v82
    v_mul_f32 v81, v81, v83
    v_cvt_pk_bf16_f32 v81, v80, v81
    v_lshlrev_b32 v32, 16, v72
    v_and_b32 v33, 0xffff0000, v72
    v_lshlrev_b32 v34, 16, v73
    v_and_b32 v35, 0xffff0000, v73
    v_lshlrev_b32 v36, 16, v74
    v_and_b32 v37, 0xffff0000, v74
    v_lshlrev_b32 v38, 16, v75
    v_and_b32 v39, 0xffff0000, v75
    v_lshlrev_b32 v80, 16, v81
    v_and_b32 v81, 0xffff0000, v81
    v_lshlrev_b32 v40, 16, v76
    v_and_b32 v41, 0xffff0000, v76
    v_lshlrev_b32 v42, 16, v77
    v_and_b32 v43, 0xffff0000, v77
    v_lshlrev_b32 v44, 16, v78
    v_and_b32 v45, 0xffff0000, v78
    v_lshlrev_b32 v46, 16, v79
    v_and_b32 v47, 0xffff0000, v79
    v_pk_mul_f32 v[32:33], v[32:33], v[80:81] op_sel_hi:[1,0]
    v_pk_mul_f32 v[34:35], v[34:35], v[80:81] op_sel_hi:[1,0]
    v_pk_mul_f32 v[36:37], v[36:37], v[80:81] op_sel_hi:[1,0]
    v_pk_mul_f32 v[38:39], v[38:39], v[80:81] op_sel_hi:[1,0]
    v_pk_fma_f32 v[32:33], v[40:41], v[80:81], v[32:33] op_sel:[0,1,0] op_sel_hi:[1,1,1]
    v_pk_fma_f32 v[34:35], v[42:43], v[80:81], v[34:35] op_sel:[0,1,0] op_sel_hi:[1,1,1]
    v_pk_fma_f32 v[36:37], v[44:45], v[80:81], v[36:37] op_sel:[0,1,0] op_sel_hi:[1,1,1]
    v_pk_fma_f32 v[38:39], v[46:47], v[80:81], v[38:39] op_sel:[0,1,0] op_sel_hi:[1,1,1]
    s_nop 0
    v_permlane32_swap_b32 v32, v36
    v_permlane32_swap_b32 v33, v37
    v_permlane32_swap_b32 v34, v38
    v_permlane32_swap_b32 v35, v39
    v_pk_add_f32 v[32:33], v[32:33], v[36:37]
    v_pk_add_f32 v[34:35], v[34:35], v[38:39]
    s_nop 1
    v_permlane16_swap_b32 v32, v34
    v_permlane16_swap_b32 v33, v35
    v_pk_add_f32 v[32:33], v[32:33], v[34:35]
    v_mov_b32 v34, s38
    v_mov_b32 v35, s39
    v_add_f32_dpp v32, v32, v32 row_ror:8 row_mask:0xf bank_mask:0xf
    v_add_f32_dpp v33, v33, v33 row_ror:8 row_mask:0xf bank_mask:0xf
nm_11:
    s_lshl_b32 s72, s34, 3
    s_add_u32 s72, s72, s36
    s_lshl_b32 s72, s72, 5
    s_add_u32 s72, s72, s35
    s_lshl_b32 s72, s72, 2
    s_add_u32 s72, s72, 16384
    v_mov_b32 v8, 0
    v_mov_b32 v9, s38
    s_waitcnt vmcnt(0)
    s_mov_b64 exec, 1
    s_cmp_eq_u32 s40, 0
    s_cbranch_scc1 slow_12
    buffer_store_dword v9, v8, s[64:67], s72 offen
    s_branch join_13
slow_12:
    buffer_store_dword v9, v8, s[64:67], s72 offen sc1
join_13:
    s_mov_b64 exec, -1
    s_cmp_lt_u32 s36, 2
    s_cbranch_scc1 nm_14
    s_mov_b32 exec_lo, 0x00ff00ff
    s_mov_b32 exec_hi, 0x00ff00ff
    s_cmp_eq_u32 s40, 0
    s_cbranch_scc1 slow_15
    buffer_store_dwordx4 v[32:35], v13, s[64:67], s76 offen
    s_branch join_16
slow_15:
    buffer_store_dwordx4 v[32:35], v13, s[64:67], s76 offen sc1
join_16:
    s_mov_b64 exec, -1
nm_14:
    s_cmp_ge_u32 s36, 4
    s_cbranch_scc1 na_17
    ds_read2_b32 v[152:153], v3 offset0:0 offset1:1
    ds_read2_b32 v[154:155], v3 offset0:2 offset1:3
    ds_read2_b32 v[184:185], v3 offset0:16 offset1:17
    ds_read2_b32 v[186:187], v3 offset0:18 offset1:19
    ds_read2_b32 v[216:217], v3 offset0:32 offset1:33
    ds_read2_b32 v[218:219], v3 offset0:34 offset1:35
    ds_read2_b32 v[248:249], v3 offset0:48 offset1:49
    ds_read2_b32 v[250:251], v3 offset0:50 offset1:51
    ds_read2_b32 v[156:157], v3 offset0:128 offset1:129
    ds_read2_b32 v[158:159], v3 offset0:130 offset1:131
    ds_read2_b32 v[188:189], v3 offset0:144 offset1:145
    ds_read2_b32 v[190:191], v3 offset0:146 offset1:147
    ds_read2_b32 v[220:221], v3 offset0:160 offset1:161
    ds_read2_b32 v[222:223], v3 offset0:162 offset1:163
    ds_read2_b32 v[252:253], v3 offset0:176 offset1:177
    ds_read2_b32 v[254:255], v3 offset0:178 offset1:179
    v_add_u32 v3, 1024, v3
na_17:
    s_lshr_b32 s73, s35, 2
    s_lshl_b32 s75, s37, 13
    s_add_u32 s75, s75, 1048576
    s_lshl_b32 s72, s34, 3
    s_add_u32 s72, s72, s73
    s_lshl_b32 s72, s72, 7
    s_add_u32 s72, s72, 16384
    s_mov_b32 s74, 0
poll_18:
    buffer_load_dword v9, v4, s[64:67], s72 offen sc1
    s_add_u32 s74, s74, 1
    s_waitcnt vmcnt(0)
    v_cmp_ne_u32 vcc, s38, v9
    s_cbranch_vccz seen_19
    s_cmp_lt_u32 s74, 131072
    s_cbranch_scc1 poll_18
seen_19:
    buffer_load_dwordx4 v[16:19], v23, s[64:67], s75 offen sc1
    s_cmp_lg_u32 s36, 7
    s_cbranch_scc1 n4_20
    buffer_load_dwordx4 v[32:35], v64, s[64:67], s77 offen offset:0 sc1
    buffer_load_dwordx4 v[36:39], v64, s[64:67], s77 offen offset:512 sc1
    buffer_load_dwordx4 v[40:43], v64, s[64:67], s77 offen offset:1024 sc1
    s_waitcnt vmcnt(3)
    s_branch j4_21
n4_20:
    s_waitcnt vmcnt(0)
j4_21:
    ds_write_b128 v5, v[16:19]
    s_waitcnt lgkmcnt(0)
    s_barrier
    s_cmp_lg_u32 s36, 7
    s_cbranch_scc1 n4_24
    s_setprio 3
    s_waitcnt vmcnt(0)
    s_mov_b32 s74, 0
    s_branch tagchk_27
tag_25:
    buffer_load_dwordx4 v[32:35], v64, s[64:67], s77 offen offset:0 sc1
    buffer_load_dwordx4 v[36:39], v64, s[64:67], s77 offen offset:512 sc1
    buffer_load_dwordx4 v[40:43], v64, s[64:67], s77 offen offset:1024 sc1
    s_add_u32 s74, s74, 1
    s_waitcnt vmcnt(0)
tagchk_27:
    v_xor_b32 v34, s38, v34
    v_bitop3_b32 v34, v35, s39, v34 bitop3:0xbe
    v_bitop3_b32 v34, v38, s38, v34 bitop3:0xbe
    v_bitop3_b32 v34, v39, s39, v34 bitop3:0xbe
    v_bitop3_b32 v34, v42, s38, v34 bitop3:0xbe
    v_bitop3_b32 v34, v43, s39, v34 bitop3:0xbe
    v_cmp_ne_u32 vcc, 0, v34
    s_cbranch_vccz tagok_26
    s_cmp_lt_u32 s74, 131072
    s_cbranch_scc1 tag_25
tagok_26:
    v_permlane16_swap_b32 v32, v33
    v_permlane16_swap_b32 v36, v37
    v_permlane16_swap_b32 v40, v41
    v_add_f32 v32, v32, v33
    v_add_f32 v36, v36, v37
    v_add_f32 v40, v40, v41
    v_add_f32_dpp v32, v32, v32 row_ror:8 row_mask:0xf bank_mask:0xf
    v_add_f32_dpp v36, v36, v36 row_ror:8 row_mask:0xf bank_mask:0xf
    v_add_f32_dpp v40, v40, v40 row_ror:8 row_mask:0xf bank_mask:0xf
    v_add_f32_dpp v32, v32, v32 row_ror:4 row_mask:0xf bank_mask:0xf
    v_add_f32_dpp v36, v36, v36 row_ror:4 row_mask:0xf bank_mask:0xf
    v_add_f32_dpp v40, v40, v40 row_ror:4 row_mask:0xf bank_mask:0xf
    v_add_f32_dpp v32, v32, v32 row_ror:2 row_mask:0xf bank_mask:0xf
    v_add_f32_dpp v36, v36, v36 row_ror:2 row_mask:0xf bank_mask:0xf
    v_add_f32_dpp v40, v40, v40 row_ror:2 row_mask:0xf bank_mask:0xf
    v_add_f32_dpp v32, v32, v32 row_ror:1 row_mask:0xf bank_mask:0xf
    v_add_f32_dpp v36, v36, v36 row_ror:1 row_mask:0xf bank_mask:0xf
    v_add_f32_dpp v40, v40, v40 row_ror:1 row_mask:0xf bank_mask:0xf
    v_mov_b32_dpp v33, v32 row_bcast:15 row_mask:0xa bank_mask:0xf
    v_mov_b32_dpp v37, v36 row_bcast:15 row_mask:0xa bank_mask:0xf
    v_mov_b32_dpp v41, v40 row_bcast:15 row_mask:0xa bank_mask:0xf
    v_cvt_pk_bf16_f32 v32, v33, v32
    v_cvt_pk_bf16_f32 v33, v37, v36
    v_cvt_pk_bf16_f32 v34, v41, v40
    v_mov_b32 v35, s38
    v_lshrrev_b32 v8, 1, v1
    s_lshl_b32 s72, s37, 5
    s_add_u32 s72, s72, 8184
    s_mov_b32 exec_lo, 0x10000
    s_mov_b32 exec_hi, 0x10000
    buffer_store_dwordx4 v[32:35], v8, s[64:67], s72 offen sc1
    s_mov_b64 exec, -1
    v_mov_b32 v8, 119264
    ds_write_b32 v8, v8
    s_setprio 0
    s_branch help_22
n4_24:
    s_cmp_ge_u32 s36, 4
    s_cbranch_scc1 help_22
    ds_read_b128 v[32:35], v7 offset:3584
    ds_read_b128 v[36:39], v7 offset:3072
    ds_read_b128 v[40:43], v7 offset:2560
    ds_read_b128 v[44:47], v7 offset:2048
    ds_read_b128 v[48:51], v7 offset:1536
    ds_read_b128 v[52:55], v7 offset:1024
    ds_read_b128 v[56:59], v7 offset:512
    ds_read_b128 v[60:63], v7 offset:0
    s_waitcnt lgkmcnt(7)
    v_mfma_f32_16x16x32_bf16 v[96:99], v[128:131], v[32:35], 0
    s_waitcnt lgkmcnt(6)
    v_mfma_f32_16x16x32_bf16 v[100:103], v[132:135], v[32:35], 0
    v_mfma_f32_16x16x32_bf16 v[100:103], v[128:131], v[36:39], v[100:103]
    s_waitcnt lgkmcnt(5)
    v_mfma_f32_16x16x32_bf16 v[104:107], v[136:139], v[32:35], 0
    v_mfma_f32_16x16x32_bf16 v[104:107], v[132:135], v[36:39], v[104:107]
    v_mfma_f32_16x16x32_bf16 v[104:107], v[128:131], v[40:43], v[104:107]
    s_waitcnt lgkmcnt(4)
    v_mfma_f32_16x16x32_bf16 v[108:111], v[140:143], v[32:35], 0
    v_mfma_f32_16x16x32_bf16 v[108:111], v[136:139], v[36:39], v[108:111]
    v_mfma_f32_16x16x32_bf16 v[108:111], v[132:135], v[40:43], v[108:111]
    v_mfma_f32_16x16x32_bf16 v[108:111], v[128:131], v[44:47], v[108:111]
    ds_read_b128 v[64:67], v7 offset:3648
    s_waitcnt lgkmcnt(4)
    v_mfma_f32_16x16x32_bf16 v[112:115], v[144:147], v[32:35], 0
    v_mfma_f32_16x16x32_bf16 v[112:115], v[140:143], v[36:39], v[112:115]
    ds_read_b128 v[68:71], v7 offset:3136
    v_mfma_f32_16x16x32_bf16 v[112:115], v[136:139], v[40:43], v[112:115]
    v_mfma_f32_16x16x32_bf16 v[112:115], v[132:135], v[44:47], v[112:115]
    ds_read_b128 v[72:75], v7 offset:2624
    v_mfma_f32_16x16x32_bf16 v[112:115], v[128:131], v[48:51], v[112:115]
    s_waitcnt lgkmcnt(5)
    v_mfma_f32_16x16x32_bf16 v[116:119], v[148:151], v[32:35], 0
    ds_read_b128 v[76:79], v7 offset:2112
    v_mfma_f32_16x16x32_bf16 v[116:119], v[144:147], v[36:39], v[116:119]
    v_mfma_f32_16x16x32_bf16 v[116:119], v[140:143], v[40:43], v[116:119]
    ds_read_b128 v[80:83], v7 offset:1600
    v_mfma_f32_16x16x32_bf16 v[116:119], v[136:139], v[44:47], v[116:119]
    v_mfma_f32_16x16x32_bf16 v[116:119], v[132:135], v[48:51], v[116:119]
    ds_read_b128 v[84:87], v7 offset:1088
    v_mfma_f32_16x16x32_bf16 v[116:119], v[128:131], v[52:55], v[116:119]
    s_waitcnt lgkmcnt(7)
    v_mfma_f32_16x16x32_bf16 v[120:123], v[152:155], v[32:35], 0
    ds_read_b128 v[88:91], v7 offset:576
    v_mfma_f32_16x16x32_bf16 v[120:123], v[148:151], v[36:39], v[120:123]
    v_mfma_f32_16x16x32_bf16 v[120:123], v[144:147], v[40:43], v[120:123]
    ds_read_b128 v[92:95], v7 offset:64
    v_mfma_f32_16x16x32_bf16 v[120:123], v[140:143], v[44:47], v[120:123]
    v_mfma_f32_16x16x32_bf16 v[120:123], v[136:139], v[48:51], v[120:123]
    v_mfma_f32_16x16x32_bf16 v[120:123], v[132:135], v[52:55], v[120:123]
    v_mfma_f32_16x16x32_bf16 v[120:123], v[128:131], v[56:59], v[120:123]
    s_waitcnt lgkmcnt(8)
    global_load_dwordx4 v[2:5], v15, s[4:5] nt
    v_mfma_f32_16x16x32_bf16 v[124:127], v[156:159], v[32:35], 0
    v_mfma_f32_16x16x32_bf16 v[124:127], v[152:155], v[36:39], v[124:127]
    v_mfma_f32_16x16x32_bf16 v[124:127], v[148:151], v[40:43], v[124:127]
    v_mfma_f32_16x16x32_bf16 v[124:127], v[144:147], v[44:47], v[124:127]
    v_mfma_f32_16x16x32_bf16 v[124:127], v[140:143], v[48:51], v[124:127]
    v_mfma_f32_16x16x32_bf16 v[124:127], v[136:139], v[52:55], v[124:127]
    v_mfma_f32_16x16x32_bf16 v[124:127], v[132:135], v[56:59], v[124:127]
    v_mfma_f32_16x16x32_bf16 v[124:127], v[128:131], v[60:63], v[124:127]
    s_waitcnt lgkmcnt(0)
    v_mfma_f32_16x16x32_bf16 v[96:99], v[160:163], v[64:67], v[96:99]
    v_mfma_f32_16x16x32_bf16 v[100:103], v[164:167], v[64:67], v[100:103]
    v_mfma_f32_16x16x32_bf16 v[100:103], v[160:163], v[68:71], v[100:103]
    v_mfma_f32_16x16x32_bf16 v[104:107], v[168:171], v[64:67], v[104:107]
    v_mfma_f32_16x16x32_bf16 v[104:107], v[164:167], v[68:71], v[104:107]
    v_mfma_f32_16x16x32_bf16 v[104:107], v[160:163], v[72:75], v[104:107]
    v_mfma_f32_16x16x32_bf16 v[108:111], v[172:175], v[64:67], v[108:111]
    v_mfma_f32_16x16x32_bf16 v[108:111], v[168:171], v[68:71], v[108:111]
    v_mfma_f32_16x16x32_bf16 v[108:111], v[164:167], v[72:75], v[108:111]
    v_mfma_f32_16x16x32_bf16 v[108:111], v[160:163], v[76:79], v[108:111]
    ds_read_b128 v[32:35], v7 offset:3712
    v_mfma_f32_16x16x32_bf16 v[112:115], v[176:179], v[64:67], v[112:115]
    v_mfma_f32_16x16x32_bf16 v[112:115], v[172:175], v[68:71], v[112:115]
    ds_read_b128 v[36:39], v7 offset:3200
    v_mfma_f32_16x16x32_bf16 v[112:115], v[168:171], v[72:75], v[112:115]
    v_mfma_f32_16x16x32_bf16 v[112:115], v[164:167], v[76:79], v[112:115]
    ds_read_b128 v[40:43], v7 offset:2688
    v_mfma_f32_16x16x32_bf16 v[112:115], v[160:163], v[80:83], v[112:115]
    v_mfma_f32_16x16x32_bf16 v[116:119], v[180:183], v[64:67], v[116:119]
    ds_read_b128 v[44:47], v7 offset:2176
    v_mfma_f32_16x16x32_bf16 v[116:119], v[176:179], v[68:71], v[116:119]
    v_mfma_f32_16x16x32_bf16 v[116:119], v[172:175], v[72:75], v[116:119]
    ds_read_b128 v[48:51], v7 offset:1664
    v_mfma_f32_16x16x32_bf16 v[116:119], v[168:171], v[76:79], v[116:119]
    v_mfma_f32_16x16x32_bf16 v[116:119], v[164:167], v[80:83], v[116:119]
    ds_read_b128 v[52:55], v7 offset:1152
    v_mfma_f32_16x16x32_bf16 v[116:119], v[160:163], v[84:87], v[116:119]
    v_mfma_f32_16x16x32_bf16 v[120:123], v[184:187], v[64:67], v[120:123]
    ds_read_b128 v[56:59], v7 offset:640
    v_mfma_f32_16x16x32_bf16 v[120:123], v[180:183], v[68:71], v[120:123]
    v_mfma_f32_16x16x32_bf16 v[120:123], v[176:179], v[72:75], v[120:123]
    ds_read_b128 v[60:63], v7 offset:128
    v_mfma_f32_16x16x32_bf16 v[120:123], v[172:175], v[76:79], v[120:123]
    v_mfma_f32_16x16x32_bf16 v[120:123], v[168:171], v[80:83], v[120:123]
    v_mfma_f32_16x16x32_bf16 v[120:123], v[164:167], v[84:87], v[120:123]
    v_mfma_f32_16x16x32_bf16 v[120:123], v[160:163], v[88:91], v[120:123]
    v_mfma_f32_16x16x32_bf16 v[124:127], v[188:191], v[64:67], v[124:127]
    v_mfma_f32_16x16x32_bf16 v[124:127], v[184:187], v[68:71], v[124:127]
    v_mfma_f32_16x16x32_bf16 v[124:127], v[180:183], v[72:75], v[124:127]
    v_mfma_f32_16x16x32_bf16 v[124:127], v[176:179], v[76:79], v[124:127]
    v_mfma_f32_16x16x32_bf16 v[124:127], v[172:175], v[80:83], v[124:127]
    v_mfma_f32_16x16x32_bf16 v[124:127], v[168:171], v[84:87], v[124:127]
    v_mfma_f32_16x16x32_bf16 v[124:127], v[164:167], v[88:91], v[124:127]
    v_mfma_f32_16x16x32_bf16 v[124:127], v[160:163], v[92:95], v[124:127]
    s_waitcnt lgkmcnt(0)
    v_mfma_f32_16x16x32_bf16 v[96:99], v[192:195], v[32:35], v[96:99]
    v_mfma_f32_16x16x32_bf16 v[100:103], v[196:199], v[32:35], v[100:103]
    v_mfma_f32_16x16x32_bf16 v[100:103], v[192:195], v[36:39], v[100:103]
    v_mfma_f32_16x16x32_bf16 v[104:107], v[200:203], v[32:35], v[104:107]
    v_mfma_f32_16x16x32_bf16 v[104:107], v[196:199], v[36:39], v[104:107]
    v_mfma_f32_16x16x32_bf16 v[104:107], v[192:195], v[40:43], v[104:107]
    v_mfma_f32_16x16x32_bf16 v[108:111], v[204:207], v[32:35], v[108:111]
    v_mfma_f32_16x16x32_bf16 v[108:111], v[200:203], v[36:39], v[108:111]
    v_mfma_f32_16x16x32_bf16 v[108:111], v[196:199], v[40:43], v[108:111]
    v_mfma_f32_16x16x32_bf16 v[108:111], v[192:195], v[44:47], v[108:111]
    ds_read_b128 v[64:67], v7 offset:3776
    v_mfma_f32_16x16x32_bf16 v[112:115], v[208:211], v[32:35], v[112:115]
    v_mfma_f32_16x16x32_bf16 v[112:115], v[204:207], v[36:39], v[112:115]
    ds_read_b128 v[68:71], v7 offset:3264
    v_mfma_f32_16x16x32_bf16 v[112:115], v[200:203], v[40:43], v[112:115]
    v_mfma_f32_16x16x32_bf16 v[112:115], v[196:199], v[44:47], v[112:115]
    ds_read_b128 v[72:75], v7 offset:2752
    v_mfma_f32_16x16x32_bf16 v[112:115], v[192:195], v[48:51], v[112:115]
    v_mfma_f32_16x16x32_bf16 v[116:119], v[212:215], v[32:35], v[116:119]
    ds_read_b128 v[76:79], v7 offset:2240
    v_mfma_f32_16x16x32_bf16 v[116:119], v[208:211], v[36:39], v[116:119]
    v_mfma_f32_16x16x32_bf16 v[116:119], v[204:207], v[40:43], v[116:119]
    ds_read_b128 v[80:83], v7 offset:1728
    v_mfma_f32_16x16x32_bf16 v[116:119], v[200:203], v[44:47], v[116:119]
    v_mfma_f32_16x16x32_bf16 v[116:119], v[196:199], v[48:51], v[116:119]
    ds_read_b128 v[84:87], v7 offset:1216
    v_mfma_f32_16x16x32_bf16 v[116:119], v[192:195], v[52:55], v[116:119]
    v_mfma_f32_16x16x32_bf16 v[120:123], v[216:219], v[32:35], v[120:123]
    ds_read_b128 v[88:91], v7 offset:704
    v_mfma_f32_16x16x32_bf16 v[120:123], v[212:215], v[36:39], v[120:123]
    v_mfma_f32_16x16x32_bf16 v[120:123], v[208:211], v[40:43], v[120:123]
    ds_read_b128 v[92:95], v7 offset:192
    v_mfma_f32_16x16x32_bf16 v[120:123], v[204:207], v[44:47], v[120:123]
    v_mfma_f32_16x16x32_bf16 v[120:123], v[200:203], v[48:51], v[120:123]
    v_mfma_f32_16x16x32_bf16 v[120:123], v[196:199], v[52:55], v[120:123]
    v_mfma_f32_16x16x32_bf16 v[120:123], v[192:195], v[56:59], v[120:123]
    v_mfma_f32_16x16x32_bf16 v[124:127], v[220:223], v[32:35], v[124:127]
    v_mfma_f32_16x16x32_bf16 v[124:127], v[216:219], v[36:39], v[124:127]
    v_mfma_f32_16x16x32_bf16 v[124:127], v[212:215], v[40:43], v[124:127]
    v_mfma_f32_16x16x32_bf16 v[124:127], v[208:211], v[44:47], v[124:127]
    v_mfma_f32_16x16x32_bf16 v[124:127], v[204:207], v[48:51], v[124:127]
    v_mfma_f32_16x16x32_bf16 v[124:127], v[200:203], v[52:55], v[124:127]
    v_mfma_f32_16x16x32_bf16 v[124:127], v[196:199], v[56:59], v[124:127]
    v_mfma_f32_16x16x32_bf16 v[124:127], v[192:195], v[60:63], v[124:127]
    s_waitcnt lgkmcnt(0)
    v_mfma_f32_16x16x32_bf16 v[96:99], v[224:227], v[64:67], v[96:99]
    v_mfma_f32_16x16x32_bf16 v[100:103], v[228:231], v[64:67], v[100:103]
    v_mfma_f32_16x16x32_bf16 v[100:103], v[224:227], v[68:71], v[100:103]
    v_mfma_f32_16x16x32_bf16 v[104:107], v[232:235], v[64:67], v[104:107]
    v_mfma_f32_16x16x32_bf16 v[104:107], v[228:231], v[68:71], v[104:107]
    v_mfma_f32_16x16x32_bf16 v[104:107], v[224:227], v[72:75], v[104:107]
    v_mfma_f32_16x16x32_bf16 v[108:111], v[236:239], v[64:67], v[108:111]
    v_mfma_f32_16x16x32_bf16 v[108:111], v[232:235], v[68:71], v[108:111]
    s_nop 0
    ds_write_b128 v6, v[96:99] offset:0
    v_mfma_f32_16x16x32_bf16 v[108:111], v[228:231], v[72:75], v[108:111]
    v_mfma_f32_16x16x32_bf16 v[108:111], v[224:227], v[76:79], v[108:111]
    ds_write_b128 v6, v[100:103] offset:1024
    v_mfma_f32_16x16x32_bf16 v[112:115], v[240:243], v[64:67], v[112:115]
    v_mfma_f32_16x16x32_bf16 v[112:115], v[236:239], v[68:71], v[112:115]
    v_mfma_f32_16x16x32_bf16 v[112:115], v[232:235], v[72:75], v[112:115]
    ds_write_b128 v6, v[104:107] offset:2048
    v_mfma_f32_16x16x32_bf16 v[112:115], v[228:231], v[76:79], v[112:115]
    v_mfma_f32_16x16x32_bf16 v[112:115], v[224:227], v[80:83], v[112:115]
    v_mfma_f32_16x16x32_bf16 v[116:119], v[244:247], v[64:67], v[116:119]
    v_mfma_f32_16x16x32_bf16 v[116:119], v[240:243], v[68:71], v[116:119]
    ds_write_b128 v6, v[108:111] offset:3072
    v_mfma_f32_16x16x32_bf16 v[116:119], v[236:239], v[72:75], v[116:119]
    v_mfma_f32_16x16x32_bf16 v[116:119], v[232:235], v[76:79], v[116:119]
    v_mfma_f32_16x16x32_bf16 v[116:119], v[228:231], v[80:83], v[116:119]
    v_mfma_f32_16x16x32_bf16 v[116:119], v[224:227], v[84:87], v[116:119]
    v_mfma_f32_16x16x32_bf16 v[120:123], v[248:251], v[64:67], v[120:123]
    ds_write_b128 v6, v[112:115] offset:4096
    v_mfma_f32_16x16x32_bf16 v[120:123], v[244:247], v[68:71], v[120:123]
    v_mfma_f32_16x16x32_bf16 v[120:123], v[240:243], v[72:75], v[120:123]
    v_mfma_f32_16x16x32_bf16 v[120:123], v[236:239], v[76:79], v[120:123]
    v_mfma_f32_16x16x32_bf16 v[120:123], v[232:235], v[80:83], v[120:123]
    v_mfma_f32_16x16x32_bf16 v[120:123], v[228:231], v[84:87], v[120:123]
    v_mfma_f32_16x16x32_bf16 v[120:123], v[224:227], v[88:91], v[120:123]
    ds_write_b128 v6, v[116:119] offset:5120
    v_mfma_f32_16x16x32_bf16 v[124:127], v[252:255], v[64:67], v[124:127]
    v_mfma_f32_16x16x32_bf16 v[124:127], v[248:251], v[68:71], v[124:127]
    v_mfma_f32_16x16x32_bf16 v[124:127], v[244:247], v[72:75], v[124:127]
    v_mfma_f32_16x16x32_bf16 v[124:127], v[240:243], v[76:79], v[124:127]
    v_mfma_f32_16x16x32_bf16 v[124:127], v[236:239], v[80:83], v[124:127]
    v_mfma_f32_16x16x32_bf16 v[124:127], v[232:235], v[84:87], v[124:127]
    v_mfma_f32_16x16x32_bf16 v[124:127], v[228:231], v[88:91], v[124:127]
    ds_write_b128 v6, v[120:123] offset:6144
    v_mfma_f32_16x16x32_bf16 v[124:127], v[224:227], v[92:95], v[124:127]
    s_nop 7
    ds_write_b128 v6, v[124:127] offset:7168
    s_branch cj_23
help_22:
    s_cmp_lg_u32 s36, 6
    s_cbranch_scc1 n6_28
    v_lshlrev_b32 v8, 10, v10
    v_lshl_add_u32 v8, v11, 4, v8
    s_lshl_b32 s72, s34, 7
    s_add_u32 s72, s72, s75
    s_cmp_eq_u32 s40, 0
    s_cbranch_scc1 slow_29
    buffer_store_dwordx4 v[68:71], v8, s[64:67], s72 offen
    s_branch join_30
slow_29:
    buffer_store_dwordx4 v[68:71], v8, s[64:67], s72 offen sc1
join_30:
    s_waitcnt vmcnt(0)
n6_28:
    s_lshl_b32 s100, s36, 10
    s_and_b32 s72, s36, 1
    s_lshl_b32 s72, s72, 2
    v_bfe_u32 v44, v1, 4, 1
    v_lshl_add_u32 v44, v44, 1, s72
    v_and_b32 v45, 7, v1
    v_xor_b32 v44, v44, v45
    v_lshrrev_b32 v45, 3, v1
    v_mul_u32_u24 v45, 3584, v45
    v_lshl_add_u32 v14, v44, 4, v45
    s_lshl_b32 s73, s35, 7
    s_mul_i32 s72, s36, 28672
    s_add_u32 s73, s73, s72
    v_add_u32 v14, s73, v14
    v_add_u32 v13, 4294852608, v14
    v_mov_b32 v8, 119264
    s_mov_b32 s74, 0
go_31:
    ds_read_b32 v9, v8
    s_add_u32 s74, s74, 1
    s_waitcnt lgkmcnt(0)
    v_cmp_eq_u32 vcc, 0, v9
    s_cbranch_vccz gone_32
    s_cmp_lt_u32 s74, 2097152
    s_cbranch_scc1 go_31
gone_32:
    global_load_dwordx4 v[2:5], v15, s[4:5] nt
    s_cmp_ge_u32 s35, 28
    s_cbranch_scc1 sp_33
    s_add_u32 s101, s34, 0
    s_and_b32 s101, s101, 7
    s_mul_i32 s101, s101, 229376
    s_add_u32 m0, s100, 0
    s_nop 0
    buffer_load_dwordx4 v14, s[52:55], s101 offen lds
    s_add_u32 m0, s100, 4294963200
    s_nop 0
    buffer_load_dwordx4 v13, s[52:55], s101 offen lds
    s_add_u32 m0, s100, 8192
    s_nop 0
    buffer_load_dwordx4 v14, s[56:59], s101 offen lds
    s_add_u32 m0, s100, 4096
    s_nop 0
    buffer_load_dwordx4 v13, s[56:59], s101 offen lds
    s_branch spe_34
sp_33:
    v_min_u32 v8, 7, v1
    s_lshl_b32 s72, s35, 2
    s_add_u32 s72, s72, s36
    s_sub_u32 s72, s72, 116
    s_mul_i32 s72, s72, 32
    s_mul_i32 s73, s34, 1792
    s_add_u32 s72, s72, s73
    v_add_lshl_u32 v8, v8, s72, 7
    global_load_dword v143, v8, s[22:23]
    v_add_u32 v8, 1024, v8
    global_load_dword v143, v8, s[22:23]
    v_add_u32 v8, 1024, v8
    global_load_dword v143, v8, s[22:23]
    v_add_u32 v8, 1024, v8
    global_load_dword v143, v8, s[22:23]
spe_34:
    s_and_b32 s17, s36, 3
    s_lshl_b32 s17, s17, 12
    v_mov_b32 v136, v13
    v_mov_b32 v137, v14
    v_and_b32 v8, 31, v1
    v_lshrrev_b32 v9, 5, v1
    v_lshlrev_b32 v8, 2, v8
    v_lshl_add_u32 v135, v9, 9, v8
    v_lshrrev_b32 v8, 4, v1
    v_and_b32 v9, 7, v1
    v_xor_b32 v10, v8, v9
    v_lshlrev_b32 v8, 1, v8
    v_xor_b32 v12, v8, v9
    v_lshrrev_b32 v9, 3, v1
    v_lshlrev_b32 v9, 10, v9
    v_lshl_add_u32 v140, v10, 4, v9
    v_xor_b32 v141, 64, v140
    v_lshl_add_u32 v142, v12, 4, v9
    s_and_b32 s72, s35, 1
    s_lshl_b32 s72, s72, 2
    s_and_b32 s73, s36, 3
    s_add_u32 s72, s72, s73
    s_mul_i32 s72, s72, 229376
    s_mov_b32 s74, s3
    s_add_u32 s16, s72, s74
    s_lshl_b32 s72, s34, 3
    s_add_u32 s72, s72, s73
    s_lshl_b32 s72, s72, 15
    s_add_u32 s98, s72, 1048576
cj_23:
    s_mov_b32 s76, 8192
    s_waitcnt lgkmcnt(0)
    s_barrier
    ds_read_b64 v[48:49], v22 offset:0
    ds_read_b128 v[32:35], v21 offset:0
    ds_read_b128 v[36:39], v21 offset:8192
    ds_read_b64 v[50:51], v22 offset:4608
    ds_read_b128 v[40:43], v21 offset:16384
    ds_read_b128 v[44:47], v21 offset:24576
    buffer_load_dwordx4 v[28:31], v23, s[64:67], s76 offen sc1
    s_waitcnt lgkmcnt(5)
    v_and_b32 v52, 0xffff0000, v49
    v_lshlrev_b32 v53, 16, v49
    v_and_b32 v54, 0xffff0000, v48
    v_lshlrev_b32 v55, 16, v48
    s_waitcnt lgkmcnt(3)
    v_pk_add_f32 v[32:33], v[32:33], v[36:37]
    v_pk_add_f32 v[34:35], v[34:35], v[38:39]
    v_fmac_f32 v32, s42, v52
    v_fmac_f32 v33, s42, v53
    v_fmac_f32 v34, s42, v54
    v_fmac_f32 v35, s42, v55
    s_waitcnt lgkmcnt(2)
    v_and_b32 v52, 0xffff0000, v51
    v_lshlrev_b32 v53, 16, v51
    v_and_b32 v54, 0xffff0000, v50
    v_lshlrev_b32 v55, 16, v50
    s_waitcnt lgkmcnt(0)
    v_pk_add_f32 v[40:41], v[40:41], v[44:45]
    v_pk_add_f32 v[42:43], v[42:43], v[46:47]
    v_fmac_f32 v40, s43, v52
    v_fmac_f32 v41, s43, v53
    v_fmac_f32 v42, s43, v54
    v_fmac_f32 v43, s43, v55
    v_cvt_pk_bf16_f32 v24, v32, v40
    v_cvt_pk_bf16_f32 v25, v33, v41
    v_cvt_pk_bf16_f32 v26, v34, v42
    v_cvt_pk_bf16_f32 v27, v35, v43
    v_min_u32 v24, -2, v24
    buffer_store_dwordx4 v[24:27], v23, s[64:67], s11 offen sc1
    v_and_b32 v9, 1, v0
    v_mul_u32_u24 v9, 3072, v9
    v_lshrrev_b32 v8, 1, v0
    v_lshl_add_u32 v8, v8, 2, v9
    v_add_u32 v8, 123904, v8
    s_waitcnt vmcnt(1)
    s_mov_b32 s74, 0
    s_branch tagchk_37
tag_35:
    buffer_load_dwordx4 v[28:31], v23, s[64:67], s76 offen sc1
    s_add_u32 s74, s74, 1
    s_waitcnt vmcnt(0)
tagchk_37:
    v_cmp_ne_u32 vcc, s38, v31
    s_cbranch_vccz tagok_36
    s_cmp_lt_u32 s74, 131072
    s_cbranch_scc1 tag_35
tagok_36:
    ds_write_b32 v8, v28 offset:0
    ds_write_b32 v8, v29 offset:1024
    ds_write_b32 v8, v30 offset:2048
    v_lshlrev_b32 v9, 4, v1
    v_add_u32 v10, 123904, v9
    s_waitcnt lgkmcnt(0)
    s_barrier
    ds_read_b128 v[96:99], v10 offset:0
    ds_read_b128 v[100:103], v10 offset:1024
    ds_read_b128 v[104:107], v10 offset:2048
    ds_read_b128 v[108:111], v10 offset:3072
    ds_read_b128 v[112:115], v10 offset:4096
    v_lshlrev_b32 v72, 16, v2
    v_and_b32 v73, 0xffff0000, v2
    v_lshlrev_b32 v74, 16, v3
    v_and_b32 v75, 0xffff0000, v3
    v_lshlrev_b32 v76, 16, v4
    v_and_b32 v77, 0xffff0000, v4
    v_lshlrev_b32 v78, 16, v5
    v_and_b32 v79, 0xffff0000, v5
    v_readfirstlane_b32 s72, v72
    s_nop 1
    v_pk_add_f32 v[80:81], v[72:73], s[72:73] op_sel_hi:[1,0] neg_lo:[0,1] neg_hi:[0,1]
    v_pk_add_f32 v[82:83], v[74:75], s[72:73] op_sel_hi:[1,0] neg_lo:[0,1] neg_hi:[0,1]
    v_pk_add_f32 v[84:85], v[76:77], s[72:73] op_sel_hi:[1,0] neg_lo:[0,1] neg_hi:[0,1]
    v_pk_add_f32 v[86:87], v[78:79], s[72:73] op_sel_hi:[1,0] neg_lo:[0,1] neg_hi:[0,1]
    v_pk_add_f32 v[40:41], v[80:81], v[82:83]
    v_pk_mul_f32 v[42:43], v[80:81], v[80:81]
    v_pk_add_f32 v[40:41], v[40:41], v[84:85]
    v_pk_fma_f32 v[42:43], v[82:83], v[82:83], v[42:43]
    v_pk_add_f32 v[40:41], v[40:41], v[86:87]
    v_pk_fma_f32 v[42:43], v[84:85], v[84:85], v[42:43]
    v_add_f32 v6, v40, v41
    v_pk_fma_f32 v[42:43], v[86:87], v[86:87], v[42:43]
    v_add_f32 v7, v42, v43
    s_nop 1
    v_permlane32_swap_b32 v6, v7
    v_add_f32 v6, v6, v7
    s_nop 1
    v_add_f32_dpp v6, v6, v6 row_ror:8 row_mask:0xf bank_mask:0xf
    s_nop 1
    v_add_f32_dpp v6, v6, v6 row_ror:4 row_mask:0xf bank_mask:0xf
    s_nop 1
    v_add_f32_dpp v6, v6, v6 row_ror:2 row_mask:0xf bank_mask:0xf
    s_nop 1
    v_add_f32_dpp v6, v6, v6 row_ror:1 row_mask:0xf bank_mask:0xf
    s_nop 1
    v_add_f32_dpp v6, v6, v6 row_bcast:15 row_mask:0xa bank_mask:0xf
    v_mov_b32 v40, 0x3b000000
    v_readlane_b32 s72, v6, 31
    v_readlane_b32 s73, v6, 63
    s_nop 0
    v_mul_f32 v6, s72, v40
    v_mul_f32 v7, s73, v40
    v_fma_f32 v7, -v6, v6, v7
    v_max_f32 v7, 0, v7
    v_add_f32 v7, 0x3727c5ac, v7
    v_rsq_f32 v7, v7
    s_nop 0
    v_pk_add_f32 v[80:81], v[80:81], v[6:7] op_sel_hi:[1,0] neg_lo:[0,1] neg_hi:[0,1]
    v_pk_add_f32 v[82:83], v[82:83], v[6:7] op_sel_hi:[1,0] neg_lo:[0,1] neg_hi:[0,1]
    v_pk_add_f32 v[84:85], v[84:85], v[6:7] op_sel_hi:[1,0] neg_lo:[0,1] neg_hi:[0,1]
    v_pk_add_f32 v[86:87], v[86:87], v[6:7] op_sel_hi:[1,0] neg_lo:[0,1] neg_hi:[0,1]
    v_pk_mul_f32 v[80:81], v[80:81], v[6:7] op_sel:[0,1] op_sel_hi:[1,1]
    v_pk_mul_f32 v[82:83], v[82:83], v[6:7] op_sel:[0,1] op_sel_hi:[1,1]
    v_pk_mul_f32 v[84:85], v[84:85], v[6:7] op_sel:[0,1] op_sel_hi:[1,1]
    v_pk_mul_f32 v[86:87], v[86:87], v[6:7] op_sel:[0,1] op_sel_hi:[1,1]
ln_38:
    s_mul_i32 s72, s36, 1040
    s_add_u32 s72, s72, 131072
    v_add_u32 v18, s72, v9
    s_mov_b32 s73, s3
    s_add_u32 s73, s73, 129024
    v_and_b32 v9, 15, v1
    v_lshl_add_u32 v9, v9, 3, s73
    ds_read_b64 v[2:3], v9
    v_lshrrev_b32 v8, 1, v0
    v_and_b32 v9, 1, v0
    v_lshlrev_b32 v16, 10, v8
    v_lshl_add_u32 v16, v9, 4, v16
    s_mul_i32 s72, s34, 262144
    s_lshl_b32 s73, s35, 5
    s_add_u32 s72, s72, s73
    s_add_u32 s75, s72, 3145728
    v_mul_u32_u24 v9, 4160, v9
    v_lshl_add_u32 v17, v8, 2, v9
    v_add_u32 v17, 131072, v17
    s_waitcnt lgkmcnt(0)
    s_waitcnt vmcnt(0)
    buffer_load_dwordx4 v[28:31], v16, s[64:67], s75 offen sc1
    s_lshl_b32 s72, s37, 13
    s_add_u32 s10, s72, 1048576
    v_lshlrev_b32 v19, 4, v0
    buffer_load_dword v139, v19, s[64:67], s10 offen sc1
    s_getpc_b64 s[78:79]
L_pc2:
    s_lshl_b32 s72, s36, 5
    s_add_u32 s72, s72, s35
    s_lshl_b32 s72, s72, 7
    s_min_u32 s72, s72, L_last-L_pc2
    v_mov_b32 v9, s72
    global_load_dword v138, v9, s[78:79]
    s_add_u32 s97, s97, 8192
    v_mov_b32 v9, 0
    buffer_load_dword v134, v9, s[64:67], s97 offen sc1
    v_lshlrev_b32 v40, 16, v96
    v_and_b32 v41, 0xffff0000, v96
    v_lshlrev_b32 v42, 16, v97
    v_and_b32 v43, 0xffff0000, v97
    v_lshlrev_b32 v44, 16, v98
    v_and_b32 v45, 0xffff0000, v98
    v_lshlrev_b32 v46, 16, v99
    v_and_b32 v47, 0xffff0000, v99
    v_lshlrev_b32 v48, 16, v100
    v_and_b32 v49, 0xffff0000, v100
    v_lshlrev_b32 v50, 16, v101
    v_and_b32 v51, 0xffff0000, v101
    v_lshlrev_b32 v52, 16, v102
    v_and_b32 v53, 0xffff0000, v102
    v_lshlrev_b32 v54, 16, v103
    v_and_b32 v55, 0xffff0000, v103
    v_pk_add_f32 v[40:41], v[40:41], v[80:81]
    v_pk_add_f32 v[42:43], v[42:43], v[82:83]
    v_pk_add_f32 v[44:45], v[44:45], v[84:85]
    v_pk_add_f32 v[46:47], v[46:47], v[86:87]
    v_pk_fma_f32 v[80:81], v[80:81], v[48:49], v[40:41]
    v_pk_fma_f32 v[82:83], v[82:83], v[50:51], v[42:43]
    v_pk_fma_f32 v[84:85], v[84:85], v[52:53], v[44:45]
    v_pk_fma_f32 v[86:87], v[86:87], v[54:55], v[46:47]
    v_lshlrev_b32 v40, 16, v104
    v_and_b32 v41, 0xffff0000, v104
    v_lshlrev_b32 v42, 16, v105
    v_and_b32 v43, 0xffff0000, v105
    v_lshlrev_b32 v44, 16, v106
    v_and_b32 v45, 0xffff0000, v106
    v_lshlrev_b32 v46, 16, v107
    v_and_b32 v47, 0xffff0000, v107
    v_pk_mul_f32 v[80:81], v[80:81], v[40:41]
    v_pk_mul_f32 v[82:83], v[82:83], v[42:43]
    v_pk_mul_f32 v[84:85], v[84:85], v[44:45]
    v_pk_mul_f32 v[86:87], v[86:87], v[46:47]
    v_lshlrev_b32 v56, 16, v108
    v_and_b32 v57, 0xffff0000, v108
    v_lshlrev_b32 v58, 16, v109
    v_and_b32 v59, 0xffff0000, v109
    v_lshlrev_b32 v60, 16, v110
    v_and_b32 v61, 0xffff0000, v110
    v_lshlrev_b32 v62, 16, v111
    v_and_b32 v63, 0xffff0000, v111
    v_lshlrev_b32 v64, 16, v112
    v_and_b32 v65, 0xffff0000, v112
    v_lshlrev_b32 v66, 16, v113
    v_and_b32 v67, 0xffff0000, v113
    v_lshlrev_b32 v68, 16, v114
    v_and_b32 v69, 0xffff0000, v114
    v_lshlrev_b32 v70, 16, v115
    v_and_b32 v71, 0xffff0000, v115
    v_mov_b32 v8, 0x3eeff558
    v_pk_fma_f32 v[64:65], v[64:65], v[8:9], v[8:9] op_sel_hi:[1,0,0]
    v_pk_fma_f32 v[66:67], v[66:67], v[8:9], v[8:9] op_sel_hi:[1,0,0]
    v_pk_fma_f32 v[68:69], v[68:69], v[8:9], v[8:9] op_sel_hi:[1,0,0]
    v_pk_fma_f32 v[70:71], v[70:71], v[8:9], v[8:9] op_sel_hi:[1,0,0]
    v_pk_mul_f32 v[56:57], v[56:57], v[8:9] op_sel_hi:[1,0]
    v_pk_mul_f32 v[58:59], v[58:59], v[8:9] op_sel_hi:[1,0]
    v_pk_mul_f32 v[60:61], v[60:61], v[8:9] op_sel_hi:[1,0]
    v_pk_mul_f32 v[62:63], v[62:63], v[8:9] op_sel_hi:[1,0]
    v_lshrrev_b32 v8, 4, v1
    v_and_b32 v9, 7, v1
    v_xor_b32 v8, v8, v9
    v_lshrrev_b32 v9, 3, v1
    v_lshlrev_b32 v9, 10, v9
    v_lshl_add_u32 v140, v8, 4, v9
    v_xor_b32 v141, 64, v140
    s_lshl_b32 s68, s36, 12
    s_add_u32 s68, s68, 65536
    v_lshl_add_u32 v20, v1, 4, s68
    s_lshl_b32 s72, s34, 3
    s_add_u32 s72, s72, s36
    s_lshl_b32 s72, s72, 8
    s_add_u32 s72, s72, s34
    s_lshl_b32 s72, s72, 7
    s_add_u32 s69, s72, 1048576
    s_waitcnt vmcnt(3)
    s_mov_b32 s74, 0
    s_branch tagchk_41
tag_39:
    buffer_load_dwordx4 v[28:31], v16, s[64:67], s75 offen sc1
    s_add_u32 s74, s74, 1
    s_waitcnt vmcnt(0)
tagchk_41:
    v_cmp_eq_u32 vcc, -1, v28
    s_cbranch_vccz tagok_40
    s_cmp_lt_u32 s74, 131072
    s_cbranch_scc1 tag_39
tagok_40:
    ds_write_b32 v17, v28 offset:0
    ds_write_b32 v17, v29 offset:1040
    ds_write_b32 v17, v30 offset:2080
    ds_write_b32 v17, v31 offset:3120
    s_waitcnt lgkmcnt(0)
    s_barrier
    ds_read_b128 v[36:39], v18
    s_cmp_lt_u32 s36, 4
    s_cbranch_scc1 hb_42
    s_cmp_ge_u32 s35, 28
    s_cbranch_scc1 sp_43
    s_add_u32 s101, s34, 1
    s_and_b32 s101, s101, 7
    s_mul_i32 s101, s101, 229376
    s_add_u32 m0, s100, 16384
    s_nop 0
    buffer_load_dwordx4 v14, s[52:55], s101 offen lds
    s_add_u32 m0, s100, 12288
    s_nop 0
    buffer_load_dwordx4 v13, s[52:55], s101 offen lds
    s_add_u32 m0, s100, 24576
    s_nop 0
    buffer_load_dwordx4 v14, s[56:59], s101 offen lds
    s_add_u32 m0, s100, 20480
    s_nop 0
    buffer_load_dwordx4 v13, s[56:59], s101 offen lds
sp_43:
hb_42:
    s_lshr_b32 s75, s35, 2
    s_and_b32 s76, s35, 3
    s_lshl_b32 s76, s76, 3
    s_add_u32 s76, s76, s36
    s_waitcnt lgkmcnt(0)
    v_lshlrev_b32 v48, 16, v36
    v_and_b32 v49, 0xffff0000, v36
    v_lshlrev_b32 v50, 16, v37
    v_and_b32 v51, 0xffff0000, v37
    v_lshlrev_b32 v52, 16, v38
    v_and_b32 v53, 0xffff0000, v38
    v_lshlrev_b32 v54, 16, v39
    v_and_b32 v55, 0xffff0000, v39
    v_pk_fma_f32 v[72:73], v[80:81], v[48:49], v[72:73]
    v_pk_fma_f32 v[74:75], v[82:83], v[50:51], v[74:75]
    v_pk_fma_f32 v[76:77], v[84:85], v[52:53], v[76:77]
    v_pk_fma_f32 v[78:79], v[86:87], v[54:55], v[78:79]
    v_readfirstlane_b32 s72, v72
    v_cvt_pk_bf16_f32 v252, v72, v73
    v_cvt_pk_bf16_f32 v253, v74, v75
    v_pk_add_f32 v[80:81], v[72:73], s[72:73] op_sel_hi:[1,0] neg_lo:[0,1] neg_hi:[0,1]
    v_pk_add_f32 v[82:83], v[74:75], s[72:73] op_sel_hi:[1,0] neg_lo:[0,1] neg_hi:[0,1]
    v_pk_add_f32 v[84:85], v[76:77], s[72:73] op_sel_hi:[1,0] neg_lo:[0,1] neg_hi:[0,1]
    v_pk_add_f32 v[86:87], v[78:79], s[72:73] op_sel_hi:[1,0] neg_lo:[0,1] neg_hi:[0,1]
    v_pk_add_f32 v[40:41], v[80:81], v[82:83]
    v_pk_mul_f32 v[42:43], v[80:81], v[80:81]
    v_pk_add_f32 v[40:41], v[40:41], v[84:85]
    v_pk_fma_f32 v[42:43], v[82:83], v[82:83], v[42:43]
    v_pk_add_f32 v[40:41], v[40:41], v[86:87]
    v_pk_fma_f32 v[42:43], v[84:85], v[84:85], v[42:43]
    v_add_f32 v6, v40, v41
    v_pk_fma_f32 v[42:43], v[86:87], v[86:87], v[42:43]
    v_add_f32 v7, v42, v43
    s_nop 1
    v_permlane32_swap_b32 v6, v7
    v_add_f32 v6, v6, v7
    s_nop 1
    v_add_f32_dpp v6, v6, v6 row_ror:8 row_mask:0xf bank_mask:0xf
    v_cvt_pk_bf16_f32 v254, v76, v77
    s_nop 0
    v_add_f32_dpp v6, v6, v6 row_ror:4 row_mask:0xf bank_mask:0xf
    v_cvt_pk_bf16_f32 v255, v78, v79
    s_nop 0
    v_add_f32_dpp v6, v6, v6 row_ror:2 row_mask:0xf bank_mask:0xf
    s_nop 1
    v_add_f32_dpp v6, v6, v6 row_ror:1 row_mask:0xf bank_mask:0xf
    s_nop 1
    v_add_f32_dpp v6, v6, v6 row_bcast:15 row_mask:0xa bank_mask:0xf
    v_mov_b32 v40, 0x3b000000
    v_readlane_b32 s72, v6, 31
    v_readlane_b32 s73, v6, 63
    s_nop 0
    v_mul_f32 v6, s72, v40
    v_mul_f32 v7, s73, v40
    v_fma_f32 v7, -v6, v6, v7
    v_max_f32 v7, 0, v7
    v_add_f32 v7, 0x3727c5ac, v7
    v_rsq_f32 v7, v7
    s_cmp_eq_u32 s40, 0
    s_cbranch_scc1 slow_45
    global_store_dwordx4 v15, v[252:255], s[28:29]
    s_branch join_46
slow_45:
    global_store_dwordx4 v15, v[252:255], s[28:29] sc1
join_46:
    v_pk_add_f32 v[80:81], v[80:81], v[6:7] op_sel_hi:[1,0] neg_lo:[0,1] neg_hi:[0,1]
    v_pk_add_f32 v[82:83], v[82:83], v[6:7] op_sel_hi:[1,0] neg_lo:[0,1] neg_hi:[0,1]
    v_pk_add_f32 v[84:85], v[84:85], v[6:7] op_sel_hi:[1,0] neg_lo:[0,1] neg_hi:[0,1]
    v_pk_add_f32 v[86:87], v[86:87], v[6:7] op_sel_hi:[1,0] neg_lo:[0,1] neg_hi:[0,1]
    v_pk_mul_f32 v[64:65], v[64:65], v[6:7] op_sel:[0,1] op_sel_hi:[1,1]
    v_pk_mul_f32 v[66:67], v[66:67], v[6:7] op_sel:[0,1] op_sel_hi:[1,1]
    v_pk_mul_f32 v[68:69], v[68:69], v[6:7] op_sel:[0,1] op_sel_hi:[1,1]
    v_pk_mul_f32 v[70:71], v[70:71], v[6:7] op_sel:[0,1] op_sel_hi:[1,1]
    v_pk_fma_f32 v[80:81], v[80:81], v[64:65], v[56:57]
    v_pk_fma_f32 v[82:83], v[82:83], v[66:67], v[58:59]
    v_pk_fma_f32 v[84:85], v[84:85], v[68:69], v[60:61]
    v_pk_fma_f32 v[86:87], v[86:87], v[70:71], v[62:63]
    v_cvt_pk_bf16_f32 v28, v80, v81
    v_cvt_pk_bf16_f32 v29, v82, v83
    v_cvt_pk_bf16_f32 v30, v84, v85
    v_cvt_pk_bf16_f32 v31, v86, v87
    v_min_u32 v28, -2, v28
    s_cmp_eq_u32 s40, 0
    s_cbranch_scc1 slow_47
    buffer_store_dwordx4 v[28:31], v19, s[64:67], s10 offen
    s_branch join_48
slow_47:
    buffer_store_dwordx4 v[28:31], v19, s[64:67], s10 offen sc1
join_48:
    s_lshl_b32 s72, s34, 3
    s_add_u32 s72, s72, s75
    s_lshl_b32 s72, s72, 5
    s_add_u32 s72, s72, s76
    s_lshl_b32 s72, s72, 2
    s_add_u32 s72, s72, 24576
    v_mov_b32 v8, 0
    v_mov_b32 v9, s38
    s_waitcnt vmcnt(0)
    s_mov_b64 exec, 1
    s_cmp_eq_u32 s40, 0
    s_cbranch_scc1 slow_49
    buffer_store_dword v9, v8, s[64:67], s72 offen
    s_branch join_50
slow_49:
    buffer_store_dword v9, v8, s[64:67], s72 offen sc1
join_50:
    s_mov_b64 exec, -1
    s_add_u32 s51, s72, 32768
    s_or_b32 s72, s2, s36
    s_cmp_lg_u32 s72, 0
    s_cbranch_scc1 noep_51
    v_mov_b32 v8, 0
    v_mov_b32 v9, s38
    s_mov_b64 exec, 1
    buffer_store_dword v9, v8, s[64:67], 0 offen sc1
    s_mov_b64 exec, -1
noep_51:
    s_cmp_lt_u32 s35, 28
    s_cbranch_scc1 work_52
    s_sub_u32 s75, s35, 28
    v_lshlrev_b32 v8, 7, v0
    v_and_b32 v10, 0x7fff, v8
    v_and_b32 v9, 0x380, v8
    v_cmp_eq_u32 vcc, s3, v9
    v_xor_b32 v9, 128, v10
    s_nop 0
    v_cndmask_b32 v10, v10, v9, vcc
    s_not_b32 s72, s38
    v_mov_b32 v12, s72
    v_lshlrev_b32 v11, 2, v1
    ds_write_b32 v11, v12 offset:49152
    s_waitcnt lgkmcnt(0)
    s_add_u32 s72, s34, 0
    s_and_b32 s72, s72, 7
    s_lshl_b32 s72, s72, 2
    s_add_u32 s72, s72, s75
    s_mul_i32 s72, s72, 57344
    v_min_u32 v9, 57216, v8
    v_add_u32 v9, s72, v9
    global_load_dword v16, v9, s[22:23]
    s_barrier
    s_add_u32 s72, s34, 7
    s_and_b32 s72, s72, 7
    s_lshl_b32 s72, s72, 2
    s_add_u32 s72, s72, s75
    s_mul_i32 s72, s72, 57344
    v_min_u32 v9, 57216, v8
    buffer_load_dword v18, v9, s[52:55], s72 offen
    buffer_load_dword v19, v9, s[56:59], s72 offen
    s_barrier
    s_barrier
    s_cmp_lt_u32 s36, 4
    s_cbranch_scc1 nd_55
    s_add_u32 m0, s17, 0
    s_add_u32 s77, s16, 0
    buffer_load_dwordx4 v142, s[60:63], s77 offen lds
    s_add_u32 m0, s17, 1024
    s_add_u32 s77, s16, 8192
    buffer_load_dwordx4 v142, s[60:63], s77 offen lds
    s_add_u32 m0, s17, 2048
    s_add_u32 s77, s16, 16384
    buffer_load_dwordx4 v142, s[60:63], s77 offen lds
    s_add_u32 m0, s17, 3072
    s_add_u32 s77, s16, 24576
    buffer_load_dwordx4 v142, s[60:63], s77 offen lds
    s_add_u32 m0, s17, 98304
    s_add_u32 s77, s16, 32768
    buffer_load_dwordx4 v142, s[60:63], s77 offen lds
    s_add_u32 m0, s17, 99328
    s_add_u32 s77, s16, 40960
    buffer_load_dwordx4 v142, s[60:63], s77 offen lds
    s_add_u32 m0, s17, 100352
    s_add_u32 s77, s16, 49152
    buffer_load_dwordx4 v142, s[60:63], s77 offen lds
    s_add_u32 m0, s17, 101376
    s_add_u32 s77, s16, 57344
    buffer_load_dwordx4 v142, s[60:63], s77 offen lds
    s_add_u32 m0, s17, 114688
    s_add_u32 s77, s16, 65536
    buffer_load_dwordx4 v142, s[60:63], s77 offen lds
    s_add_u32 m0, s17, 115712
    s_add_u32 s77, s16, 73728
    buffer_load_dwordx4 v142, s[60:63], s77 offen lds
    s_add_u32 m0, s17, 116736
    s_add_u32 s77, s16, 81920
    buffer_load_dwordx4 v142, s[60:63], s77 offen lds
    s_add_u32 m0, s17, 117760
    s_add_u32 s77, s16, 90112
    buffer_load_dwordx4 v142, s[60:63], s77 offen lds
    s_add_u32 m0, s17, 16384
    s_add_u32 s77, s16, 98304
    buffer_load_dwordx4 v142, s[60:63], s77 offen lds
    s_add_u32 m0, s17, 17408
    s_add_u32 s77, s16, 106496
    buffer_load_dwordx4 v142, s[60:63], s77 offen lds
    s_add_u32 m0, s17, 18432
    s_add_u32 s77, s16, 114688
    buffer_load_dwordx4 v142, s[60:63], s77 offen lds
    s_add_u32 m0, s17, 19456
    s_add_u32 s77, s16, 122880
    buffer_load_dwordx4 v142, s[60:63], s77 offen lds
    s_add_u32 m0, s17, 65536
    s_add_u32 s77, s16, 131072
    buffer_load_dwordx4 v142, s[60:63], s77 offen lds
    s_add_u32 m0, s17, 66560
    s_add_u32 s77, s16, 139264
    buffer_load_dwordx4 v142, s[60:63], s77 offen lds
    s_add_u32 m0, s17, 67584
    s_add_u32 s77, s16, 147456
    buffer_load_dwordx4 v142, s[60:63], s77 offen lds
    s_add_u32 m0, s17, 68608
    s_add_u32 s77, s16, 155648
    buffer_load_dwordx4 v142, s[60:63], s77 offen lds
    s_add_u32 m0, s17, 81920
    s_add_u32 s77, s16, 163840
    buffer_load_dwordx4 v142, s[60:63], s77 offen lds
    s_add_u32 m0, s17, 82944
    s_add_u32 s77, s16, 172032
    buffer_load_dwordx4 v142, s[60:63], s77 offen lds
    s_add_u32 m0, s17, 83968
    s_add_u32 s77, s16, 180224
    buffer_load_dwordx4 v142, s[60:63], s77 offen lds
    s_add_u32 m0, s17, 84992
    s_add_u32 s77, s16, 188416
    buffer_load_dwordx4 v142, s[60:63], s77 offen lds
    s_add_u32 m0, s17, 32768
    s_add_u32 s77, s16, 196608
    buffer_load_dwordx4 v142, s[60:63], s77 offen lds
    s_add_u32 m0, s17, 33792
    s_add_u32 s77, s16, 204800
    buffer_load_dwordx4 v142, s[60:63], s77 offen lds
    s_add_u32 m0, s17, 34816
    s_add_u32 s77, s16, 212992
    buffer_load_dwordx4 v142, s[60:63], s77 offen lds
    s_add_u32 m0, s17, 35840
    s_add_u32 s77, s16, 221184
    buffer_load_dwordx4 v142, s[60:63], s77 offen lds
nd_55:
    s_barrier
    s_waitcnt vmcnt(0)
    v_and_b32 v8, 31, v1
    v_lshlrev_b32 v8, 2, v8
    s_lshl_b32 s72, s34, 3
    s_add_u32 s72, s72, s36
    s_lshl_b32 s72, s72, 7
    s_add_u32 s72, s72, 24576
    s_mov_b32 s74, 0
poll_56:
    buffer_load_dword v9, v8, s[64:67], s72 offen sc1
    s_add_u32 s74, s74, 1
    s_waitcnt vmcnt(0)
    v_cmp_ne_u32 vcc, s38, v9
    s_cbranch_vccz seen_57
    s_cmp_lt_u32 s74, 131072
    s_cbranch_scc1 poll_56
seen_57:
    s_barrier
    s_cmp_ge_u32 s36, 4
    s_cbranch_scc1 spb_54
    s_lshl_b32 s72, s36, 2
    v_lshrrev_b32 v8, 4, v1
    v_add_u32 v8, s72, v8
    v_and_b32 v9, 15, v1
    v_add_u32 v10, v8, v9
    v_and_b32 v10, 15, v10
    v_lshl_add_u32 v10, v9, 4, v10
    v_lshlrev_b32 v10, 4, v10
    s_lshl_b32 s72, s34, 3
    s_and_b32 s73, s35, 3
    s_add_u32 s72, s72, s73
    s_lshl_b32 s72, s72, 15
    s_add_u32 s72, s72, s3
    v_lshlrev_b32 v8, 10, v8
    v_lshl_add_u32 v8, v9, 3, v8
    v_add_u32 v13, s72, v8
    v_xor_b32 v12, 0x8000, v13
    v_and_b32 v11, 3, v1
    v_lshlrev_b32 v11, 2, v11
    v_add_u32 v11, 49152, v11
    v_lshlrev_b32 v6, 4, v1
    s_xor_b32 s72, s35, 1
    s_lshl_b32 s72, s72, 2
    v_mov_b32 v14, s72
    s_add_u32 s8, s36, 4
    v_and_b32 v5, 0xffff0000, v3
    v_lshlrev_b32 v4, 16, v3
    v_and_b32 v3, 0xffff0000, v2
    v_lshlrev_b32 v2, 16, v2
    v_mul_f32 v2, 0x4091afa4, v2
    v_mul_f32 v3, 0x4091afa4, v3
    v_mul_f32 v4, 0x4091afa4, v4
    v_mul_f32 v5, 0x4091afa4, v5
    s_mov_b64 s[44:45], s[28:29]
    s_mov_b32 s46, 2097152
    s_mov_b32 s47, 0x20000
    s_lshr_b32 s72, s35, 2
    s_sub_u32 s73, s72, 3
    s_min_u32 s72, s72, s73
    s_sub_u32 s73, s72, 3
    s_min_u32 s72, s72, s73
    s_mov_b32 s48, 16384
    s_cmp_eq_u32 s72, 1
    s_cselect_b32 s48, 131072, s48
    s_cmp_eq_u32 s72, 2
    s_cselect_b32 s48, 147456, s48
    s_mov_b32 s49, 131072
    s_cmp_eq_u32 s72, 1
    s_cselect_b32 s49, 147456, s49
    s_cmp_eq_u32 s72, 2
    s_cselect_b32 s49, 16384, s49
    s_mov_b32 s50, 147456
    s_cmp_eq_u32 s72, 1
    s_cselect_b32 s50, 16384, s50
    s_cmp_eq_u32 s72, 2
    s_cselect_b32 s50, 131072, s50
    s_branch L_fin
spb_54:
    v_lshrrev_b32 v9, 2, v1
    v_bfe_u32 v8, v1, 3, 2
    v_lshlrev_b32 v9, 7, v9
    v_lshl_add_u32 v9, v8, 5, v9
    v_and_b32 v8, 3, v1
    v_lshl_add_u32 v9, v8, 3, v9
    v_add_u32 v16, s17, v9
    v_xor_b32 v17, 32, v16
    v_xor_b32 v18, 64, v16
    v_xor_b32 v19, 96, v16
    v_add_u32 v20, 65536, v16
    v_add_u32 v21, 65536, v17
    v_add_u32 v22, 65536, v18
    v_add_u32 v23, 65536, v19
    s_and_b32 s4, s36, 3
    s_and_b32 s5, s35, 3
    s_and_b32 s72, s35, 1
    s_lshl_b32 s72, s72, 2
    s_add_u32 s72, s72, s4
    s_mul_i32 s10, s72, 7
    s_lshr_b32 s72, s10, 1
    v_and_b32 v8, 3, v1
    v_add_lshl_u32 v8, v8, s72, 2
    v_bfe_u32 v9, v1, 2, 1
    v_lshl_add_u32 v15, v9, 8, v8
    s_mul_i32 s73, s34, 917504
    s_lshl_b32 s10, s10, 10
    s_add_u32 s10, s10, s73
    s_add_u32 s10, s10, 11534336
    s_mul_i32 s72, s5, 114688
    s_add_u32 s6, s10, s72
    s_xor_b32 s72, s5, 1
    s_mul_i32 s72, s72, 114688
    s_add_u32 s7, s10, s72
    s_and_b32 s8, s35, 2
    s_lshl_b32 s8, s8, 1
    s_lshl_b32 s72, s34, 3
    s_add_u32 s72, s72, s8
    s_lshl_b32 s72, s72, 7
    s_add_u32 s10, s72, 40960
    s_add_u32 s9, s72, 49152
    v_lshlrev_b32 v6, 4, v1
    v_add_u32 v7, 4096, v6
    v_lshrrev_b32 v9, 4, v1
    v_add_u32 v10, v9, v1
    v_and_b32 v8, 48, v1
    s_lshl_b32 s72, s4, 12
    v_add_u32 v13, 12, v10
    v_and_b32 v13, 15, v13
    v_or_b32 v13, v13, v8
    v_lshl_add_u32 v13, v13, 4, s72
    v_add_u32 v12, 8, v10
    v_and_b32 v12, 15, v12
    v_or_b32 v12, v12, v8
    v_lshl_add_u32 v12, v12, 4, s72
    v_add_u32 v11, 4, v10
    v_and_b32 v11, 15, v11
    v_or_b32 v11, v11, v8
    v_lshl_add_u32 v11, v11, 4, s72
    v_add_u32 v10, 0, v10
    v_and_b32 v10, 15, v10
    v_or_b32 v10, v10, v8
    v_lshl_add_u32 v10, v10, 4, s72
    s_lshl_b32 s72, s4, 2
    s_add_u32 s72, s72, 49152
    v_mov_b32 v14, s72
    v_mov_b32 v5, s38
    s_lshr_b32 s72, s35, 2
    s_sub_u32 s73, s72, 3
    s_min_u32 s72, s72, s73
    s_sub_u32 s73, s72, 3
    s_min_u32 s72, s72, s73
    s_mov_b32 s48, 57344
    s_cmp_eq_u32 s72, 1
    s_cselect_b32 s48, 458752, s48
    s_cmp_eq_u32 s72, 2
    s_cselect_b32 s48, 516096, s48
    s_mov_b32 s49, 458752
    s_cmp_eq_u32 s72, 1
    s_cselect_b32 s49, 516096, s49
    s_cmp_eq_u32 s72, 2
    s_cselect_b32 s49, 57344, s49
    s_mov_b32 s50, 516096
    s_cmp_eq_u32 s72, 1
    s_cselect_b32 s50, 57344, s50
    s_cmp_eq_u32 s72, 2
    s_cselect_b32 s50, 458752, s50
    ds_read_b64_tr_b16 v[144:145], v16 offset:0
    ds_read_b64_tr_b16 v[146:147], v16 offset:2048
    ds_read_b64_tr_b16 v[148:149], v17 offset:0
    ds_read_b64_tr_b16 v[150:151], v17 offset:2048
    ds_read_b64_tr_b16 v[152:153], v18 offset:0
    ds_read_b64_tr_b16 v[154:155], v18 offset:2048
    ds_read_b64_tr_b16 v[156:157], v19 offset:0
    ds_read_b64_tr_b16 v[158:159], v19 offset:2048
    ds_read_b64_tr_b16 v[160:161], v20 offset:32768
    ds_read_b64_tr_b16 v[162:163], v20 offset:34816
    ds_read_b64_tr_b16 v[164:165], v21 offset:32768
    ds_read_b64_tr_b16 v[166:167], v21 offset:34816
    ds_read_b64_tr_b16 v[168:169], v22 offset:32768
    ds_read_b64_tr_b16 v[170:171], v22 offset:34816
    ds_read_b64_tr_b16 v[172:173], v23 offset:32768
    ds_read_b64_tr_b16 v[174:175], v23 offset:34816
    ds_read_b64_tr_b16 v[176:177], v20 offset:49152
    ds_read_b64_tr_b16 v[178:179], v20 offset:51200
    ds_read_b64_tr_b16 v[180:181], v21 offset:49152
    ds_read_b64_tr_b16 v[182:183], v21 offset:51200
    ds_read_b64_tr_b16 v[184:185], v22 offset:49152
    ds_read_b64_tr_b16 v[186:187], v22 offset:51200
    ds_read_b64_tr_b16 v[188:189], v23 offset:49152
    ds_read_b64_tr_b16 v[190:191], v23 offset:51200
    ds_read_b64_tr_b16 v[192:193], v16 offset:16384
    ds_read_b64_tr_b16 v[194:195], v16 offset:18432
    ds_read_b64_tr_b16 v[196:197], v17 offset:16384
    ds_read_b64_tr_b16 v[198:199], v17 offset:18432
    ds_read_b64_tr_b16 v[200:201], v18 offset:16384
    ds_read_b64_tr_b16 v[202:203], v18 offset:18432
    ds_read_b64_tr_b16 v[204:205], v19 offset:16384
    ds_read_b64_tr_b16 v[206:207], v19 offset:18432
    ds_read_b64_tr_b16 v[208:209], v20 offset:0
    ds_read_b64_tr_b16 v[210:211], v20 offset:2048
    ds_read_b64_tr_b16 v[212:213], v21 offset:0
    ds_read_b64_tr_b16 v[214:215], v21 offset:2048
    ds_read_b64_tr_b16 v[216:217], v22 offset:0
    ds_read_b64_tr_b16 v[218:219], v22 offset:2048
    ds_read_b64_tr_b16 v[220:221], v23 offset:0
    ds_read_b64_tr_b16 v[222:223], v23 offset:2048
    ds_read_b64_tr_b16 v[224:225], v20 offset:16384
    ds_read_b64_tr_b16 v[226:227], v20 offset:18432
    ds_read_b64_tr_b16 v[228:229], v21 offset:16384
    ds_read_b64_tr_b16 v[230:231], v21 offset:18432
    ds_read_b64_tr_b16 v[232:233], v22 offset:16384
    ds_read_b64_tr_b16 v[234:235], v22 offset:18432
    ds_read_b64_tr_b16 v[236:237], v23 offset:16384
    ds_read_b64_tr_b16 v[238:239], v23 offset:18432
    ds_read_b64_tr_b16 v[240:241], v16 offset:32768
    ds_read_b64_tr_b16 v[242:243], v16 offset:34816
    ds_read_b64_tr_b16 v[244:245], v17 offset:32768
    ds_read_b64_tr_b16 v[246:247], v17 offset:34816
    ds_read_b64_tr_b16 v[248:249], v18 offset:32768
    ds_read_b64_tr_b16 v[250:251], v18 offset:34816
    ds_read_b64_tr_b16 v[252:253], v19 offset:32768
    ds_read_b64_tr_b16 v[254:255], v19 offset:34816
    s_branch L_mul
work_52:
    s_cmp_ge_u32 s36, 4
    s_cbranch_scc1 loader_53
L_g1:
    s_add_u32 m0, s68, 0
    s_add_u32 s77, s69, 0
    buffer_load_dwordx4 v140, s[64:67], s77 offen sc1 lds
    s_add_u32 m0, s68, 1024
    s_add_u32 s77, s69, 8192
    buffer_load_dwordx4 v141, s[64:67], s77 offen sc1 lds
    s_add_u32 m0, s68, 2048
    s_add_u32 s77, s69, 16384
    buffer_load_dwordx4 v140, s[64:67], s77 offen sc1 lds
    s_add_u32 m0, s68, 3072
    s_add_u32 s77, s69, 24576
    buffer_load_dwordx4 v141, s[64:67], s77 offen sc1 lds
    v_lshrrev_b32 v8, 4, v1
    v_bfe_u32 v9, v1, 2, 2
    v_lshl_add_u32 v10, v8, 3, v9
    v_lshlrev_b32 v10, 7, v10
    v_bfe_u32 v9, v1, 3, 2
    v_lshl_add_u32 v10, v9, 5, v10
    v_and_b32 v9, 3, v1
    v_lshl_add_u32 v240, v9, 3, v10
    v_xor_b32 v241, 32, v240
    v_xor_b32 v242, 64, v240
    v_xor_b32 v243, 96, v240
    v_bfe_u32 v9, v1, 1, 3
    v_xor_b32 v8, v8, v9
    v_and_b32 v9, 15, v1
    v_lshlrev_b32 v9, 7, v9
    v_lshl_add_u32 v8, v8, 4, v9
    s_and_b32 s17, s36, 3
    s_lshl_b32 s17, s17, 12
    s_add_u32 s72, s17, 65536
    v_add_u32 v244, s72, v8
    v_xor_b32 v245, 64, v244
    v_add_u32 v246, 65536, v244
    v_add_u32 v247, 65536, v245
    s_lshl_b32 s72, s36, 2
    v_lshrrev_b32 v8, 4, v1
    v_add_u32 v8, s72, v8
    v_and_b32 v9, 15, v1
    v_add_u32 v10, v8, v9
    v_and_b32 v10, 15, v10
    v_lshl_add_u32 v10, v9, 4, v10
    v_lshlrev_b32 v10, 4, v10
    s_lshl_b32 s72, s34, 3
    s_and_b32 s73, s35, 3
    s_add_u32 s72, s72, s73
    s_lshl_b32 s72, s72, 15
    s_add_u32 s72, s72, s3
    v_lshlrev_b32 v8, 10, v8
    v_lshl_add_u32 v8, v9, 3, v8
    v_add_u32 v13, s72, v8
    v_xor_b32 v12, 0x8000, v13
    v_and_b32 v11, 3, v1
    v_lshlrev_b32 v11, 2, v11
    v_add_u32 v11, 49152, v11
    v_lshlrev_b32 v6, 4, v1
    s_xor_b32 s72, s35, 1
    s_lshl_b32 s72, s72, 2
    v_mov_b32 v14, s72
    s_add_u32 s8, s36, 4
    v_and_b32 v5, 0xffff0000, v3
    v_lshlrev_b32 v4, 16, v3
    v_and_b32 v3, 0xffff0000, v2
    v_lshlrev_b32 v2, 16, v2
    v_mul_f32 v2, 0x4091afa4, v2
    v_mul_f32 v3, 0x4091afa4, v3
    v_mul_f32 v4, 0x4091afa4, v4
    v_mul_f32 v5, 0x4091afa4, v5
    s_mov_b64 s[44:45], s[28:29]
    s_mov_b32 s46, 2097152
    s_mov_b32 s47, 0x20000
    s_lshr_b32 s72, s35, 2
    s_sub_u32 s73, s72, 3
    s_min_u32 s72, s72, s73
    s_sub_u32 s73, s72, 3
    s_min_u32 s72, s72, s73
    s_mov_b32 s48, 16384
    s_cmp_eq_u32 s72, 1
    s_cselect_b32 s48, 131072, s48
    s_cmp_eq_u32 s72, 2
    s_cselect_b32 s48, 147456, s48
    s_mov_b32 s49, 131072
    s_cmp_eq_u32 s72, 1
    s_cselect_b32 s49, 147456, s49
    s_cmp_eq_u32 s72, 2
    s_cselect_b32 s49, 16384, s49
    s_mov_b32 s50, 147456
    s_cmp_eq_u32 s72, 1
    s_cselect_b32 s50, 16384, s50
    s_cmp_eq_u32 s72, 2
    s_cselect_b32 s50, 131072, s50
    v_mov_b32 v248, 0x409d30fc
    v_mov_b32 v251, s38
    v_and_b32 v8, 1, v1
    v_bfe_u32 v9, v1, 1, 1
    v_mul_u32_u24 v9, 8192, v9
    v_lshl_add_u32 v250, v8, 7, v9
    s_lshl_b32 s72, s34, 2
    s_add_u32 s72, s72, s36
    s_lshl_b32 s72, s72, 6
    s_add_u32 s72, s72, s35
    s_lshl_b32 s72, s72, 2
    s_add_u32 s10, s72, 40960
    s_mul_i32 s72, s36, 114688
    s_lshl_b32 s73, s35, 11
    s_add_u32 s72, s72, s73
    s_mul_i32 s73, s34, 917504
    s_add_u32 s72, s72, s73
    s_add_u32 s76, s72, 11534336
    s_mov_b32 s74, 0
    s_branch h0c_59
h0_58:
    s_add_u32 m0, s68, 0
    s_add_u32 s77, s69, 0
    buffer_load_dwordx4 v140, s[64:67], s77 offen sc1 lds
    s_add_u32 m0, s68, 1024
    s_add_u32 s77, s69, 8192
    buffer_load_dwordx4 v141, s[64:67], s77 offen sc1 lds
    s_add_u32 m0, s68, 2048
    s_add_u32 s77, s69, 16384
    buffer_load_dwordx4 v140, s[64:67], s77 offen sc1 lds
    s_add_u32 m0, s68, 3072
    s_add_u32 s77, s69, 24576
    buffer_load_dwordx4 v141, s[64:67], s77 offen sc1 lds
h0c_59:
    s_waitcnt vmcnt(0)
    ds_read2st64_b32 v[22:23], v20 offset0:0 offset1:4
    ds_read2st64_b32 v[24:25], v20 offset0:8 offset1:12
    s_add_u32 s74, s74, 1
    s_waitcnt lgkmcnt(0)
    v_max3_u32 v22, v22, v23, v24
    v_max_u32 v22, v22, v25
    v_cmp_eq_u32 vcc, -1, v22
    s_cbranch_vccz h0d_60
    s_cmp_lt_u32 s74, 131072
    s_cbranch_scc1 h0_58
h0d_60:
    s_barrier
    ds_read_b128 v[144:147], v244 offset:0
    ds_read_b128 v[148:151], v245 offset:0
    ds_read_b64_tr_b16 v[208:209], v240 offset:0
    ds_read_b64_tr_b16 v[210:211], v240 offset:512
    ds_read_b64_tr_b16 v[212:213], v240 offset:4096
    ds_read_b64_tr_b16 v[214:215], v240 offset:4608
    ds_read_b128 v[152:155], v244 offset:2048
    ds_read_b128 v[156:159], v245 offset:2048
    ds_read_b128 v[160:163], v244 offset:16384
    ds_read_b128 v[164:167], v245 offset:16384
    ds_read_b128 v[168:171], v244 offset:18432
    ds_read_b128 v[172:175], v245 offset:18432
    s_waitcnt lgkmcnt(6)
    v_mfma_f32_16x16x32_bf16 v[16:19], v[208:211], v[144:147], 0
    ds_read_b64_tr_b16 v[216:217], v240 offset:8192
    v_mfma_f32_16x16x32_bf16 v[16:19], v[212:215], v[148:151], v[16:19]
    ds_read_b64_tr_b16 v[218:219], v240 offset:8704
    s_waitcnt lgkmcnt(6)
    v_mfma_f32_16x16x32_bf16 v[48:51], v[212:215], v[156:159], 0
    ds_read_b64_tr_b16 v[220:221], v240 offset:12288
    v_mfma_f32_16x16x32_bf16 v[48:51], v[208:211], v[152:155], v[48:51]
    ds_read_b64_tr_b16 v[222:223], v240 offset:12800
    s_waitcnt lgkmcnt(6)
    v_mfma_f32_16x16x32_bf16 v[80:83], v[208:211], v[160:163], 0
    ds_read_b64_tr_b16 v[224:225], v241 offset:0
    v_mfma_f32_16x16x32_bf16 v[80:83], v[212:215], v[164:167], v[80:83]
    ds_read_b64_tr_b16 v[226:227], v241 offset:512
    s_waitcnt lgkmcnt(6)
    v_mfma_f32_16x16x32_bf16 v[112:115], v[212:215], v[172:175], 0
    ds_read_b64_tr_b16 v[228:229], v241 offset:4096
    v_mfma_f32_16x16x32_bf16 v[112:115], v[208:211], v[168:171], v[112:115]
    ds_read_b64_tr_b16 v[230:231], v241 offset:4608
    s_waitcnt lgkmcnt(4)
    v_mfma_f32_16x16x32_bf16 v[116:119], v[216:219], v[168:171], 0
    ds_read_b64_tr_b16 v[232:233], v241 offset:8192
    v_mfma_f32_16x16x32_bf16 v[116:119], v[220:223], v[172:175], v[116:119]
    ds_read_b64_tr_b16 v[234:235], v241 offset:8704
    v_mfma_f32_16x16x32_bf16 v[84:87], v[220:223], v[164:167], 0
    ds_read_b64_tr_b16 v[236:237], v241 offset:12288
    v_mfma_f32_16x16x32_bf16 v[84:87], v[216:219], v[160:163], v[84:87]
    ds_read_b64_tr_b16 v[238:239], v241 offset:12800
    v_mfma_f32_16x16x32_bf16 v[52:55], v[216:219], v[152:155], 0
    ds_read_b64_tr_b16 v[208:209], v242 offset:0
    v_mfma_f32_16x16x32_bf16 v[52:55], v[220:223], v[156:159], v[52:55]
    ds_read_b64_tr_b16 v[210:211], v242 offset:512
    v_mfma_f32_16x16x32_bf16 v[20:23], v[220:223], v[148:151], 0
    ds_read_b64_tr_b16 v[212:213], v242 offset:4096
    v_mfma_f32_16x16x32_bf16 v[20:23], v[216:219], v[144:147], v[20:23]
    ds_read_b64_tr_b16 v[214:215], v242 offset:4608
    s_waitcnt lgkmcnt(8)
    v_mfma_f32_16x16x32_bf16 v[24:27], v[224:227], v[144:147], 0
    ds_read_b64_tr_b16 v[216:217], v242 offset:8192
    v_mfma_f32_16x16x32_bf16 v[24:27], v[228:231], v[148:151], v[24:27]
    ds_read_b64_tr_b16 v[218:219], v242 offset:8704
    v_mfma_f32_16x16x32_bf16 v[56:59], v[228:231], v[156:159], 0
    ds_read_b64_tr_b16 v[220:221], v242 offset:12288
    v_mfma_f32_16x16x32_bf16 v[56:59], v[224:227], v[152:155], v[56:59]
    ds_read_b64_tr_b16 v[222:223], v242 offset:12800
    v_mfma_f32_16x16x32_bf16 v[88:91], v[224:227], v[160:163], 0
    v_mfma_f32_16x16x32_bf16 v[88:91], v[228:231], v[164:167], v[88:91]
    v_mfma_f32_16x16x32_bf16 v[120:123], v[228:231], v[172:175], 0
    v_mfma_f32_16x16x32_bf16 v[120:123], v[224:227], v[168:171], v[120:123]
    s_waitcnt lgkmcnt(8)
    v_mfma_f32_16x16x32_bf16 v[124:127], v[232:235], v[168:171], 0
    ds_read_b64_tr_b16 v[224:225], v243 offset:0
    v_mfma_f32_16x16x32_bf16 v[124:127], v[236:239], v[172:175], v[124:127]
    ds_read_b64_tr_b16 v[226:227], v243 offset:512
    v_mfma_f32_16x16x32_bf16 v[92:95], v[236:239], v[164:167], 0
    ds_read_b64_tr_b16 v[228:229], v243 offset:4096
    v_mfma_f32_16x16x32_bf16 v[92:95], v[232:235], v[160:163], v[92:95]
    ds_read_b64_tr_b16 v[230:231], v243 offset:4608
    v_mfma_f32_16x16x32_bf16 v[60:63], v[232:235], v[152:155], 0
    v_mfma_f32_16x16x32_bf16 v[60:63], v[236:239], v[156:159], v[60:63]
    v_mfma_f32_16x16x32_bf16 v[28:31], v[236:239], v[148:151], 0
    v_mfma_f32_16x16x32_bf16 v[28:31], v[232:235], v[144:147], v[28:31]
    s_waitcnt lgkmcnt(8)
    v_mfma_f32_16x16x32_bf16 v[32:35], v[208:211], v[144:147], 0
    ds_read_b64_tr_b16 v[232:233], v243 offset:8192
    v_mfma_f32_16x16x32_bf16 v[32:35], v[212:215], v[148:151], v[32:35]
    ds_read_b64_tr_b16 v[234:235], v243 offset:8704
    v_mfma_f32_16x16x32_bf16 v[64:67], v[212:215], v[156:159], 0
    ds_read_b64_tr_b16 v[236:237], v243 offset:12288
    v_mfma_f32_16x16x32_bf16 v[64:67], v[208:211], v[152:155], v[64:67]
    ds_read_b64_tr_b16 v[238:239], v243 offset:12800
    v_mfma_f32_16x16x32_bf16 v[96:99], v[208:211], v[160:163], 0
    v_mfma_f32_16x16x32_bf16 v[96:99], v[212:215], v[164:167], v[96:99]
    v_mfma_f32_16x16x32_bf16 v[128:131], v[212:215], v[172:175], 0
    v_mfma_f32_16x16x32_bf16 v[128:131], v[208:211], v[168:171], v[128:131]
    s_waitcnt lgkmcnt(8)
    v_mfma_f32_16x16x32_bf16 v[132:135], v[216:219], v[168:171], 0
    v_mfma_f32_16x16x32_bf16 v[132:135], v[220:223], v[172:175], v[132:135]
    v_mfma_f32_16x16x32_bf16 v[100:103], v[220:223], v[164:167], 0
    v_mfma_f32_16x16x32_bf16 v[100:103], v[216:219], v[160:163], v[100:103]
    v_mfma_f32_16x16x32_bf16 v[68:71], v[216:219], v[152:155], 0
    v_mfma_f32_16x16x32_bf16 v[68:71], v[220:223], v[156:159], v[68:71]
    v_mfma_f32_16x16x32_bf16 v[36:39], v[220:223], v[148:151], 0
    v_mfma_f32_16x16x32_bf16 v[36:39], v[216:219], v[144:147], v[36:39]
    s_waitcnt lgkmcnt(0)
    s_barrier
    v_mfma_f32_16x16x32_bf16 v[40:43], v[224:227], v[144:147], 0
    ds_read_b128 v[176:179], v246 offset:0
    v_mfma_f32_16x16x32_bf16 v[40:43], v[228:231], v[148:151], v[40:43]
    ds_read_b128 v[180:183], v247 offset:0
    v_mfma_f32_16x16x32_bf16 v[72:75], v[228:231], v[156:159], 0
    ds_read_b64_tr_b16 v[208:209], v240 offset:16384
    v_mfma_f32_16x16x32_bf16 v[72:75], v[224:227], v[152:155], v[72:75]
    ds_read_b64_tr_b16 v[210:211], v240 offset:16896
    v_mfma_f32_16x16x32_bf16 v[104:107], v[224:227], v[160:163], 0
    ds_read_b64_tr_b16 v[212:213], v240 offset:20480
    v_mfma_f32_16x16x32_bf16 v[104:107], v[228:231], v[164:167], v[104:107]
    ds_read_b64_tr_b16 v[214:215], v240 offset:20992
    v_mfma_f32_16x16x32_bf16 v[136:139], v[228:231], v[172:175], 0
    ds_read_b128 v[184:187], v246 offset:2048
    v_mfma_f32_16x16x32_bf16 v[136:139], v[224:227], v[168:171], v[136:139]
    ds_read_b128 v[188:191], v247 offset:2048
    v_mfma_f32_16x16x32_bf16 v[140:143], v[232:235], v[168:171], 0
    ds_read_b128 v[192:195], v246 offset:16384
    v_mfma_f32_16x16x32_bf16 v[140:143], v[236:239], v[172:175], v[140:143]
    ds_read_b128 v[196:199], v247 offset:16384
    v_mfma_f32_16x16x32_bf16 v[108:111], v[236:239], v[164:167], 0
    ds_read_b128 v[200:203], v246 offset:18432
    v_mfma_f32_16x16x32_bf16 v[108:111], v[232:235], v[160:163], v[108:111]
    ds_read_b128 v[204:207], v247 offset:18432
    v_mfma_f32_16x16x32_bf16 v[76:79], v[232:235], v[152:155], 0
    ds_read_b64_tr_b16 v[216:217], v240 offset:24576
    v_mfma_f32_16x16x32_bf16 v[76:79], v[236:239], v[156:159], v[76:79]
    ds_read_b64_tr_b16 v[218:219], v240 offset:25088
    v_mfma_f32_16x16x32_bf16 v[44:47], v[236:239], v[148:151], 0
    ds_read_b64_tr_b16 v[220:221], v240 offset:28672
    v_mfma_f32_16x16x32_bf16 v[44:47], v[232:235], v[144:147], v[44:47]
    ds_read_b64_tr_b16 v[222:223], v240 offset:29184
    s_waitcnt lgkmcnt(10)
    v_mfma_f32_16x16x32_bf16 v[16:19], v[208:211], v[176:179], v[16:19]
    ds_read_b64_tr_b16 v[224:225], v241 offset:16384
    v_mfma_f32_16x16x32_bf16 v[16:19], v[212:215], v[180:183], v[16:19]
    ds_read_b64_tr_b16 v[226:227], v241 offset:16896
    s_waitcnt lgkmcnt(10)
    v_mfma_f32_16x16x32_bf16 v[48:51], v[212:215], v[188:191], v[48:51]
    ds_read_b64_tr_b16 v[228:229], v241 offset:20480
    v_mfma_f32_16x16x32_bf16 v[48:51], v[208:211], v[184:187], v[48:51]
    ds_read_b64_tr_b16 v[230:231], v241 offset:20992
    s_waitcnt lgkmcnt(10)
    v_mfma_f32_16x16x32_bf16 v[80:83], v[208:211], v[192:195], v[80:83]
    ds_read_b64_tr_b16 v[232:233], v241 offset:24576
    v_mfma_f32_16x16x32_bf16 v[80:83], v[212:215], v[196:199], v[80:83]
    ds_read_b64_tr_b16 v[234:235], v241 offset:25088
    s_waitcnt lgkmcnt(10)
    v_mfma_f32_16x16x32_bf16 v[112:115], v[212:215], v[204:207], v[112:115]
    ds_read_b64_tr_b16 v[236:237], v241 offset:28672
    v_mfma_f32_16x16x32_bf16 v[112:115], v[208:211], v[200:203], v[112:115]
    ds_read_b64_tr_b16 v[238:239], v241 offset:29184
    s_waitcnt lgkmcnt(8)
    v_mfma_f32_16x16x32_bf16 v[116:119], v[216:219], v[200:203], v[116:119]
    ds_read_b64_tr_b16 v[208:209], v242 offset:16384
    v_mfma_f32_16x16x32_bf16 v[116:119], v[220:223], v[204:207], v[116:119]
    ds_read_b64_tr_b16 v[210:211], v242 offset:16896
    v_mfma_f32_16x16x32_bf16 v[84:87], v[220:223], v[196:199], v[84:87]
    ds_read_b64_tr_b16 v[212:213], v242 offset:20480
    v_mfma_f32_16x16x32_bf16 v[84:87], v[216:219], v[192:195], v[84:87]
    ds_read_b64_tr_b16 v[214:215], v242 offset:20992
    v_mfma_f32_16x16x32_bf16 v[52:55], v[216:219], v[184:187], v[52:55]
    v_mfma_f32_16x16x32_bf16 v[52:55], v[220:223], v[188:191], v[52:55]
    v_mfma_f32_16x16x32_bf16 v[20:23], v[220:223], v[180:183], v[20:23]
    v_mfma_f32_16x16x32_bf16 v[20:23], v[216:219], v[176:179], v[20:23]
    s_waitcnt lgkmcnt(8)
    v_mfma_f32_16x16x32_bf16 v[24:27], v[224:227], v[176:179], v[24:27]
    ds_read_b64_tr_b16 v[216:217], v242 offset:24576
    v_mfma_f32_16x16x32_bf16 v[24:27], v[228:231], v[180:183], v[24:27]
    ds_read_b64_tr_b16 v[218:219], v242 offset:25088
    v_mfma_f32_16x16x32_bf16 v[56:59], v[228:231], v[188:191], v[56:59]
    ds_read_b64_tr_b16 v[220:221], v242 offset:28672
    v_mfma_f32_16x16x32_bf16 v[56:59], v[224:227], v[184:187], v[56:59]
    ds_read_b64_tr_b16 v[222:223], v242 offset:29184
    v_mfma_f32_16x16x32_bf16 v[88:91], v[224:227], v[192:195], v[88:91]
    v_mfma_f32_16x16x32_bf16 v[88:91], v[228:231], v[196:199], v[88:91]
    v_mfma_f32_16x16x32_bf16 v[120:123], v[228:231], v[204:207], v[120:123]
    v_mfma_f32_16x16x32_bf16 v[120:123], v[224:227], v[200:203], v[120:123]
    s_waitcnt lgkmcnt(8)
    v_mfma_f32_16x16x32_bf16 v[124:127], v[232:235], v[200:203], v[124:127]
    ds_read_b64_tr_b16 v[224:225], v243 offset:16384
    v_mfma_f32_16x16x32_bf16 v[124:127], v[236:239], v[204:207], v[124:127]
    ds_read_b64_tr_b16 v[226:227], v243 offset:16896
    v_mfma_f32_16x16x32_bf16 v[92:95], v[236:239], v[196:199], v[92:95]
    ds_read_b64_tr_b16 v[228:229], v243 offset:20480
    v_mfma_f32_16x16x32_bf16 v[92:95], v[232:235], v[192:195], v[92:95]
    ds_read_b64_tr_b16 v[230:231], v243 offset:20992
    v_mfma_f32_16x16x32_bf16 v[60:63], v[232:235], v[184:187], v[60:63]
    v_mfma_f32_16x16x32_bf16 v[60:63], v[236:239], v[188:191], v[60:63]
    v_mfma_f32_16x16x32_bf16 v[28:31], v[236:239], v[180:183], v[28:31]
    v_mfma_f32_16x16x32_bf16 v[28:31], v[232:235], v[176:179], v[28:31]
    s_waitcnt lgkmcnt(8)
    v_mfma_f32_16x16x32_bf16 v[32:35], v[208:211], v[176:179], v[32:35]
    ds_read_b64_tr_b16 v[232:233], v243 offset:24576
    v_mfma_f32_16x16x32_bf16 v[32:35], v[212:215], v[180:183], v[32:35]
    ds_read_b64_tr_b16 v[234:235], v243 offset:25088
    v_mfma_f32_16x16x32_bf16 v[64:67], v[212:215], v[188:191], v[64:67]
    ds_read_b64_tr_b16 v[236:237], v243 offset:28672
    v_mfma_f32_16x16x32_bf16 v[64:67], v[208:211], v[184:187], v[64:67]
    ds_read_b64_tr_b16 v[238:239], v243 offset:29184
    v_mfma_f32_16x16x32_bf16 v[96:99], v[208:211], v[192:195], v[96:99]
    v_mfma_f32_16x16x32_bf16 v[96:99], v[212:215], v[196:199], v[96:99]
    v_mfma_f32_16x16x32_bf16 v[128:131], v[212:215], v[204:207], v[128:131]
    v_mfma_f32_16x16x32_bf16 v[128:131], v[208:211], v[200:203], v[128:131]
    s_waitcnt lgkmcnt(8)
    v_mfma_f32_16x16x32_bf16 v[132:135], v[216:219], v[200:203], v[132:135]
    v_mfma_f32_16x16x32_bf16 v[132:135], v[220:223], v[204:207], v[132:135]
    v_mfma_f32_16x16x32_bf16 v[100:103], v[220:223], v[196:199], v[100:103]
    v_mfma_f32_16x16x32_bf16 v[100:103], v[216:219], v[192:195], v[100:103]
    v_mfma_f32_16x16x32_bf16 v[68:71], v[216:219], v[184:187], v[68:71]
    v_mfma_f32_16x16x32_bf16 v[68:71], v[220:223], v[188:191], v[68:71]
    v_mfma_f32_16x16x32_bf16 v[36:39], v[220:223], v[180:183], v[36:39]
    v_mfma_f32_16x16x32_bf16 v[36:39], v[216:219], v[176:179], v[36:39]
    s_waitcnt lgkmcnt(0)
    s_barrier
    v_mfma_f32_16x16x32_bf16 v[40:43], v[224:227], v[176:179], v[40:43]
    ds_read_b128 v[144:147], v244 offset:32768
    v_mfma_f32_16x16x32_bf16 v[40:43], v[228:231], v[180:183], v[40:43]
    ds_read_b128 v[148:151], v245 offset:32768
    v_mfma_f32_16x16x32_bf16 v[72:75], v[228:231], v[188:191], v[72:75]
    ds_read_b64_tr_b16 v[208:209], v240 offset:32768
    v_mfma_f32_16x16x32_bf16 v[72:75], v[224:227], v[184:187], v[72:75]
    ds_read_b64_tr_b16 v[210:211], v240 offset:33280
    v_mfma_f32_16x16x32_bf16 v[104:107], v[224:227], v[192:195], v[104:107]
    ds_read_b64_tr_b16 v[212:213], v240 offset:36864
    v_mfma_f32_16x16x32_bf16 v[104:107], v[228:231], v[196:199], v[104:107]
    ds_read_b64_tr_b16 v[214:215], v240 offset:37376
    v_mfma_f32_16x16x32_bf16 v[136:139], v[228:231], v[204:207], v[136:139]
    ds_read_b128 v[152:155], v244 offset:34816
    v_mfma_f32_16x16x32_bf16 v[136:139], v[224:227], v[200:203], v[136:139]
    ds_read_b128 v[156:159], v245 offset:34816
    v_mfma_f32_16x16x32_bf16 v[140:143], v[232:235], v[200:203], v[140:143]
    ds_read_b128 v[160:163], v244 offset:49152
    v_mfma_f32_16x16x32_bf16 v[140:143], v[236:239], v[204:207], v[140:143]
    ds_read_b128 v[164:167], v245 offset:49152
    v_mfma_f32_16x16x32_bf16 v[108:111], v[236:239], v[196:199], v[108:111]
    ds_read_b128 v[168:171], v244 offset:51200
    v_mfma_f32_16x16x32_bf16 v[108:111], v[232:235], v[192:195], v[108:111]
    ds_read_b128 v[172:175], v245 offset:51200
    v_mfma_f32_16x16x32_bf16 v[76:79], v[232:235], v[184:187], v[76:79]
    ds_read_b64_tr_b16 v[216:217], v240 offset:40960
    v_mfma_f32_16x16x32_bf16 v[76:79], v[236:239], v[188:191], v[76:79]
    ds_read_b64_tr_b16 v[218:219], v240 offset:41472
    v_mfma_f32_16x16x32_bf16 v[44:47], v[236:239], v[180:183], v[44:47]
    ds_read_b64_tr_b16 v[220:221], v240 offset:45056
    v_mfma_f32_16x16x32_bf16 v[44:47], v[232:235], v[176:179], v[44:47]
    ds_read_b64_tr_b16 v[222:223], v240 offset:45568
    s_waitcnt lgkmcnt(10)
    v_mfma_f32_16x16x32_bf16 v[16:19], v[208:211], v[144:147], v[16:19]
    ds_read_b64_tr_b16 v[224:225], v241 offset:32768
    v_mfma_f32_16x16x32_bf16 v[16:19], v[212:215], v[148:151], v[16:19]
    ds_read_b64_tr_b16 v[226:227], v241 offset:33280
    s_waitcnt lgkmcnt(10)
    v_mfma_f32_16x16x32_bf16 v[48:51], v[212:215], v[156:159], v[48:51]
    ds_read_b64_tr_b16 v[228:229], v241 offset:36864
    v_mfma_f32_16x16x32_bf16 v[48:51], v[208:211], v[152:155], v[48:51]
    ds_read_b64_tr_b16 v[230:231], v241 offset:37376
    s_waitcnt lgkmcnt(10)
    v_mfma_f32_16x16x32_bf16 v[80:83], v[208:211], v[160:163], v[80:83]
    ds_read_b64_tr_b16 v[232:233], v241 offset:40960
    v_mfma_f32_16x16x32_bf16 v[80:83], v[212:215], v[164:167], v[80:83]
    ds_read_b64_tr_b16 v[234:235], v241 offset:41472
    s_waitcnt lgkmcnt(10)
    v_mfma_f32_16x16x32_bf16 v[112:115], v[212:215], v[172:175], v[112:115]
    ds_read_b64_tr_b16 v[236:237], v241 offset:45056
    v_mfma_f32_16x16x32_bf16 v[112:115], v[208:211], v[168:171], v[112:115]
    ds_read_b64_tr_b16 v[238:239], v241 offset:45568
    s_waitcnt lgkmcnt(8)
    v_mfma_f32_16x16x32_bf16 v[116:119], v[216:219], v[168:171], v[116:119]
    ds_read_b64_tr_b16 v[208:209], v242 offset:32768
    v_mfma_f32_16x16x32_bf16 v[116:119], v[220:223], v[172:175], v[116:119]
    ds_read_b64_tr_b16 v[210:211], v242 offset:33280
    v_mfma_f32_16x16x32_bf16 v[84:87], v[220:223], v[164:167], v[84:87]
    ds_read_b64_tr_b16 v[212:213], v242 offset:36864
    v_mfma_f32_16x16x32_bf16 v[84:87], v[216:219], v[160:163], v[84:87]
    ds_read_b64_tr_b16 v[214:215], v242 offset:37376
    v_mfma_f32_16x16x32_bf16 v[52:55], v[216:219], v[152:155], v[52:55]
    v_mfma_f32_16x16x32_bf16 v[52:55], v[220:223], v[156:159], v[52:55]
    v_mfma_f32_16x16x32_bf16 v[20:23], v[220:223], v[148:151], v[20:23]
    v_mfma_f32_16x16x32_bf16 v[20:23], v[216:219], v[144:147], v[20:23]
    s_waitcnt lgkmcnt(8)
    v_mfma_f32_16x16x32_bf16 v[24:27], v[224:227], v[144:147], v[24:27]
    ds_read_b64_tr_b16 v[216:217], v242 offset:40960
    v_mfma_f32_16x16x32_bf16 v[24:27], v[228:231], v[148:151], v[24:27]
    ds_read_b64_tr_b16 v[218:219], v242 offset:41472
    v_mfma_f32_16x16x32_bf16 v[56:59], v[228:231], v[156:159], v[56:59]
    ds_read_b64_tr_b16 v[220:221], v242 offset:45056
    v_mfma_f32_16x16x32_bf16 v[56:59], v[224:227], v[152:155], v[56:59]
    ds_read_b64_tr_b16 v[222:223], v242 offset:45568
    v_mfma_f32_16x16x32_bf16 v[88:91], v[224:227], v[160:163], v[88:91]
    v_mfma_f32_16x16x32_bf16 v[88:91], v[228:231], v[164:167], v[88:91]
    v_mfma_f32_16x16x32_bf16 v[120:123], v[228:231], v[172:175], v[120:123]
    v_mfma_f32_16x16x32_bf16 v[120:123], v[224:227], v[168:171], v[120:123]
    s_waitcnt lgkmcnt(8)
    v_mfma_f32_16x16x32_bf16 v[124:127], v[232:235], v[168:171], v[124:127]
    ds_read_b64_tr_b16 v[224:225], v243 offset:32768
    v_mfma_f32_16x16x32_bf16 v[124:127], v[236:239], v[172:175], v[124:127]
    ds_read_b64_tr_b16 v[226:227], v243 offset:33280
    v_mfma_f32_16x16x32_bf16 v[92:95], v[236:239], v[164:167], v[92:95]
    ds_read_b64_tr_b16 v[228:229], v243 offset:36864
    v_mfma_f32_16x16x32_bf16 v[92:95], v[232:235], v[160:163], v[92:95]
    ds_read_b64_tr_b16 v[230:231], v243 offset:37376
    v_mfma_f32_16x16x32_bf16 v[60:63], v[232:235], v[152:155], v[60:63]
    v_mfma_f32_16x16x32_bf16 v[60:63], v[236:239], v[156:159], v[60:63]
    v_mfma_f32_16x16x32_bf16 v[28:31], v[236:239], v[148:151], v[28:31]
    v_mfma_f32_16x16x32_bf16 v[28:31], v[232:235], v[144:147], v[28:31]
    s_waitcnt lgkmcnt(8)
    v_mfma_f32_16x16x32_bf16 v[32:35], v[208:211], v[144:147], v[32:35]
    ds_read_b64_tr_b16 v[232:233], v243 offset:40960
    v_mfma_f32_16x16x32_bf16 v[32:35], v[212:215], v[148:151], v[32:35]
    ds_read_b64_tr_b16 v[234:235], v243 offset:41472
    v_mfma_f32_16x16x32_bf16 v[64:67], v[212:215], v[156:159], v[64:67]
    ds_read_b64_tr_b16 v[236:237], v243 offset:45056
    v_mfma_f32_16x16x32_bf16 v[64:67], v[208:211], v[152:155], v[64:67]
    ds_read_b64_tr_b16 v[238:239], v243 offset:45568
    v_mfma_f32_16x16x32_bf16 v[96:99], v[208:211], v[160:163], v[96:99]
    v_mfma_f32_16x16x32_bf16 v[96:99], v[212:215], v[164:167], v[96:99]
    v_mfma_f32_16x16x32_bf16 v[128:131], v[212:215], v[172:175], v[128:131]
    v_mfma_f32_16x16x32_bf16 v[128:131], v[208:211], v[168:171], v[128:131]
    s_waitcnt lgkmcnt(8)
    v_mfma_f32_16x16x32_bf16 v[132:135], v[216:219], v[168:171], v[132:135]
    v_mfma_f32_16x16x32_bf16 v[132:135], v[220:223], v[172:175], v[132:135]
    v_mfma_f32_16x16x32_bf16 v[100:103], v[220:223], v[164:167], v[100:103]
    v_mfma_f32_16x16x32_bf16 v[100:103], v[216:219], v[160:163], v[100:103]
    v_mfma_f32_16x16x32_bf16 v[68:71], v[216:219], v[152:155], v[68:71]
    v_mfma_f32_16x16x32_bf16 v[68:71], v[220:223], v[156:159], v[68:71]
    v_mfma_f32_16x16x32_bf16 v[36:39], v[220:223], v[148:151], v[36:39]
    v_mfma_f32_16x16x32_bf16 v[36:39], v[216:219], v[144:147], v[36:39]
    s_waitcnt lgkmcnt(0)
    s_barrier
    v_mfma_f32_16x16x32_bf16 v[40:43], v[224:227], v[144:147], v[40:43]
    ds_read_b128 v[176:179], v244 offset:0
    v_mfma_f32_16x16x32_bf16 v[40:43], v[228:231], v[148:151], v[40:43]
    ds_read_b128 v[180:183], v245 offset:0
    v_mfma_f32_16x16x32_bf16 v[72:75], v[228:231], v[156:159], v[72:75]
    ds_read_b64_tr_b16 v[208:209], v240 offset:49152
    v_mfma_f32_16x16x32_bf16 v[72:75], v[224:227], v[152:155], v[72:75]
    ds_read_b64_tr_b16 v[210:211], v240 offset:49664
    v_mfma_f32_16x16x32_bf16 v[104:107], v[224:227], v[160:163], v[104:107]
    ds_read_b64_tr_b16 v[212:213], v240 offset:53248
    v_mfma_f32_16x16x32_bf16 v[104:107], v[228:231], v[164:167], v[104:107]
    ds_read_b64_tr_b16 v[214:215], v240 offset:53760
    v_mfma_f32_16x16x32_bf16 v[136:139], v[228:231], v[172:175], v[136:139]
    ds_read_b128 v[184:187], v244 offset:2048
    v_mfma_f32_16x16x32_bf16 v[136:139], v[224:227], v[168:171], v[136:139]
    ds_read_b128 v[188:191], v245 offset:2048
    v_mfma_f32_16x16x32_bf16 v[140:143], v[232:235], v[168:171], v[140:143]
    ds_read_b128 v[192:195], v244 offset:16384
    v_mfma_f32_16x16x32_bf16 v[140:143], v[236:239], v[172:175], v[140:143]
    ds_read_b128 v[196:199], v245 offset:16384
    v_mfma_f32_16x16x32_bf16 v[108:111], v[236:239], v[164:167], v[108:111]
    ds_read_b128 v[200:203], v244 offset:18432
    v_mfma_f32_16x16x32_bf16 v[108:111], v[232:235], v[160:163], v[108:111]
    ds_read_b128 v[204:207], v245 offset:18432
    v_mfma_f32_16x16x32_bf16 v[76:79], v[232:235], v[152:155], v[76:79]
    ds_read_b64_tr_b16 v[216:217], v240 offset:57344
    v_mfma_f32_16x16x32_bf16 v[76:79], v[236:239], v[156:159], v[76:79]
    ds_read_b64_tr_b16 v[218:219], v240 offset:57856
    v_mfma_f32_16x16x32_bf16 v[44:47], v[236:239], v[148:151], v[44:47]
    ds_read_b64_tr_b16 v[220:221], v240 offset:61440
    v_mfma_f32_16x16x32_bf16 v[44:47], v[232:235], v[144:147], v[44:47]
    ds_read_b64_tr_b16 v[222:223], v240 offset:61952
    s_waitcnt lgkmcnt(10)
    v_mfma_f32_16x16x32_bf16 v[16:19], v[208:211], v[176:179], v[16:19]
    ds_read_b64_tr_b16 v[224:225], v241 offset:49152
    v_mfma_f32_16x16x32_bf16 v[16:19], v[212:215], v[180:183], v[16:19]
    ds_read_b64_tr_b16 v[226:227], v241 offset:49664
    s_waitcnt lgkmcnt(10)
    v_mfma_f32_16x16x32_bf16 v[48:51], v[212:215], v[188:191], v[48:51]
    ds_read_b64_tr_b16 v[228:229], v241 offset:53248
    v_mfma_f32_16x16x32_bf16 v[48:51], v[208:211], v[184:187], v[48:51]
    ds_read_b64_tr_b16 v[230:231], v241 offset:53760
    s_waitcnt lgkmcnt(10)
    v_mfma_f32_16x16x32_bf16 v[80:83], v[208:211], v[192:195], v[80:83]
    ds_read_b64_tr_b16 v[232:233], v241 offset:57344
    v_mfma_f32_16x16x32_bf16 v[80:83], v[212:215], v[196:199], v[80:83]
    ds_read_b64_tr_b16 v[234:235], v241 offset:57856
    s_waitcnt lgkmcnt(10)
    v_mfma_f32_16x16x32_bf16 v[112:115], v[212:215], v[204:207], v[112:115]
    ds_read_b64_tr_b16 v[236:237], v241 offset:61440
    v_mfma_f32_16x16x32_bf16 v[112:115], v[208:211], v[200:203], v[112:115]
    ds_read_b64_tr_b16 v[238:239], v241 offset:61952
    s_waitcnt lgkmcnt(8)
    v_mfma_f32_16x16x32_bf16 v[116:119], v[216:219], v[200:203], v[116:119]
    ds_read_b64_tr_b16 v[208:209], v242 offset:49152
    v_mfma_f32_16x16x32_bf16 v[116:119], v[220:223], v[204:207], v[116:119]
    ds_read_b64_tr_b16 v[210:211], v242 offset:49664
    v_mfma_f32_16x16x32_bf16 v[84:87], v[220:223], v[196:199], v[84:87]
    ds_read_b64_tr_b16 v[212:213], v242 offset:53248
    v_mfma_f32_16x16x32_bf16 v[84:87], v[216:219], v[192:195], v[84:87]
    ds_read_b64_tr_b16 v[214:215], v242 offset:53760
    v_mfma_f32_16x16x32_bf16 v[52:55], v[216:219], v[184:187], v[52:55]
    v_mfma_f32_16x16x32_bf16 v[52:55], v[220:223], v[188:191], v[52:55]
    v_mfma_f32_16x16x32_bf16 v[20:23], v[220:223], v[180:183], v[20:23]
    v_mfma_f32_16x16x32_bf16 v[20:23], v[216:219], v[176:179], v[20:23]
    s_waitcnt lgkmcnt(8)
    v_mfma_f32_16x16x32_bf16 v[24:27], v[224:227], v[176:179], v[24:27]
    ds_read_b64_tr_b16 v[216:217], v242 offset:57344
    v_mfma_f32_16x16x32_bf16 v[24:27], v[228:231], v[180:183], v[24:27]
    ds_read_b64_tr_b16 v[218:219], v242 offset:57856
    v_mfma_f32_16x16x32_bf16 v[56:59], v[228:231], v[188:191], v[56:59]
    ds_read_b64_tr_b16 v[220:221], v242 offset:61440
    v_mfma_f32_16x16x32_bf16 v[56:59], v[224:227], v[184:187], v[56:59]
    ds_read_b64_tr_b16 v[222:223], v242 offset:61952
    v_mfma_f32_16x16x32_bf16 v[88:91], v[224:227], v[192:195], v[88:91]
    v_mfma_f32_16x16x32_bf16 v[88:91], v[228:231], v[196:199], v[88:91]
    v_mfma_f32_16x16x32_bf16 v[120:123], v[228:231], v[204:207], v[120:123]
    v_mfma_f32_16x16x32_bf16 v[120:123], v[224:227], v[200:203], v[120:123]
    s_waitcnt lgkmcnt(8)
    v_mfma_f32_16x16x32_bf16 v[124:127], v[232:235], v[200:203], v[124:127]
    ds_read_b64_tr_b16 v[224:225], v243 offset:49152
    v_mfma_f32_16x16x32_bf16 v[124:127], v[236:239], v[204:207], v[124:127]
    ds_read_b64_tr_b16 v[226:227], v243 offset:49664
    v_mfma_f32_16x16x32_bf16 v[92:95], v[236:239], v[196:199], v[92:95]
    ds_read_b64_tr_b16 v[228:229], v243 offset:53248
    v_mfma_f32_16x16x32_bf16 v[92:95], v[232:235], v[192:195], v[92:95]
    ds_read_b64_tr_b16 v[230:231], v243 offset:53760
    v_mfma_f32_16x16x32_bf16 v[60:63], v[232:235], v[184:187], v[60:63]
    v_mfma_f32_16x16x32_bf16 v[60:63], v[236:239], v[188:191], v[60:63]
    v_mfma_f32_16x16x32_bf16 v[28:31], v[236:239], v[180:183], v[28:31]
    v_mfma_f32_16x16x32_bf16 v[28:31], v[232:235], v[176:179], v[28:31]
    s_waitcnt lgkmcnt(8)
    v_mfma_f32_16x16x32_bf16 v[32:35], v[208:211], v[176:179], v[32:35]
    ds_read_b64_tr_b16 v[232:233], v243 offset:57344
    v_mfma_f32_16x16x32_bf16 v[32:35], v[212:215], v[180:183], v[32:35]
    ds_read_b64_tr_b16 v[234:235], v243 offset:57856
    v_mfma_f32_16x16x32_bf16 v[64:67], v[212:215], v[188:191], v[64:67]
    ds_read_b64_tr_b16 v[236:237], v243 offset:61440
    v_mfma_f32_16x16x32_bf16 v[64:67], v[208:211], v[184:187], v[64:67]
    ds_read_b64_tr_b16 v[238:239], v243 offset:61952
    v_mfma_f32_16x16x32_bf16 v[96:99], v[208:211], v[192:195], v[96:99]
    v_mfma_f32_16x16x32_bf16 v[96:99], v[212:215], v[196:199], v[96:99]
    v_mfma_f32_16x16x32_bf16 v[128:131], v[212:215], v[204:207], v[128:131]
    v_mfma_f32_16x16x32_bf16 v[128:131], v[208:211], v[200:203], v[128:131]
    s_waitcnt lgkmcnt(8)
    v_mfma_f32_16x16x32_bf16 v[132:135], v[216:219], v[200:203], v[132:135]
    v_mfma_f32_16x16x32_bf16 v[132:135], v[220:223], v[204:207], v[132:135]
    v_mfma_f32_16x16x32_bf16 v[100:103], v[220:223], v[196:199], v[100:103]
    v_mfma_f32_16x16x32_bf16 v[100:103], v[216:219], v[192:195], v[100:103]
    v_mfma_f32_16x16x32_bf16 v[68:71], v[216:219], v[184:187], v[68:71]
    v_mfma_f32_16x16x32_bf16 v[68:71], v[220:223], v[188:191], v[68:71]
    v_mfma_f32_16x16x32_bf16 v[36:39], v[220:223], v[180:183], v[36:39]
    v_mfma_f32_16x16x32_bf16 v[36:39], v[216:219], v[176:179], v[36:39]
    s_waitcnt lgkmcnt(0)
    s_barrier
    v_mfma_f32_16x16x32_bf16 v[40:43], v[224:227], v[176:179], v[40:43]
    ds_read_b128 v[144:147], v246 offset:0
    v_mfma_f32_16x16x32_bf16 v[40:43], v[228:231], v[180:183], v[40:43]
    ds_read_b128 v[148:151], v247 offset:0
    v_mfma_f32_16x16x32_bf16 v[72:75], v[228:231], v[188:191], v[72:75]
    ds_read_b64_tr_b16 v[208:209], v240 offset:0
    v_mfma_f32_16x16x32_bf16 v[72:75], v[224:227], v[184:187], v[72:75]
    ds_read_b64_tr_b16 v[210:211], v240 offset:512
    v_mfma_f32_16x16x32_bf16 v[104:107], v[224:227], v[192:195], v[104:107]
    ds_read_b64_tr_b16 v[212:213], v240 offset:4096
    v_mfma_f32_16x16x32_bf16 v[104:107], v[228:231], v[196:199], v[104:107]
    ds_read_b64_tr_b16 v[214:215], v240 offset:4608
    v_mfma_f32_16x16x32_bf16 v[136:139], v[228:231], v[204:207], v[136:139]
    ds_read_b128 v[152:155], v246 offset:2048
    v_mfma_f32_16x16x32_bf16 v[136:139], v[224:227], v[200:203], v[136:139]
    ds_read_b128 v[156:159], v247 offset:2048
    v_mfma_f32_16x16x32_bf16 v[140:143], v[232:235], v[200:203], v[140:143]
    ds_read_b128 v[160:163], v246 offset:16384
    v_mfma_f32_16x16x32_bf16 v[140:143], v[236:239], v[204:207], v[140:143]
    ds_read_b128 v[164:167], v247 offset:16384
    v_mfma_f32_16x16x32_bf16 v[108:111], v[236:239], v[196:199], v[108:111]
    ds_read_b128 v[168:171], v246 offset:18432
    v_mfma_f32_16x16x32_bf16 v[108:111], v[232:235], v[192:195], v[108:111]
    ds_read_b128 v[172:175], v247 offset:18432
    v_mfma_f32_16x16x32_bf16 v[76:79], v[232:235], v[184:187], v[76:79]
    ds_read_b64_tr_b16 v[216:217], v240 offset:8192
    v_mfma_f32_16x16x32_bf16 v[76:79], v[236:239], v[188:191], v[76:79]
    ds_read_b64_tr_b16 v[218:219], v240 offset:8704
    v_mfma_f32_16x16x32_bf16 v[44:47], v[236:239], v[180:183], v[44:47]
    ds_read_b64_tr_b16 v[220:221], v240 offset:12288
    v_mfma_f32_16x16x32_bf16 v[44:47], v[232:235], v[176:179], v[44:47]
    ds_read_b64_tr_b16 v[222:223], v240 offset:12800
    s_waitcnt lgkmcnt(10)
    v_mfma_f32_16x16x32_bf16 v[16:19], v[208:211], v[144:147], v[16:19]
    ds_read_b64_tr_b16 v[224:225], v241 offset:0
    v_mfma_f32_16x16x32_bf16 v[16:19], v[212:215], v[148:151], v[16:19]
    ds_read_b64_tr_b16 v[226:227], v241 offset:512
    s_waitcnt lgkmcnt(10)
    v_mfma_f32_16x16x32_bf16 v[48:51], v[212:215], v[156:159], v[48:51]
    ds_read_b64_tr_b16 v[228:229], v241 offset:4096
    v_mfma_f32_16x16x32_bf16 v[48:51], v[208:211], v[152:155], v[48:51]
    ds_read_b64_tr_b16 v[230:231], v241 offset:4608
    s_waitcnt lgkmcnt(10)
    v_mfma_f32_16x16x32_bf16 v[80:83], v[208:211], v[160:163], v[80:83]
    ds_read_b64_tr_b16 v[232:233], v241 offset:8192
    v_mfma_f32_16x16x32_bf16 v[80:83], v[212:215], v[164:167], v[80:83]
    ds_read_b64_tr_b16 v[234:235], v241 offset:8704
    s_waitcnt lgkmcnt(10)
    v_mfma_f32_16x16x32_bf16 v[112:115], v[212:215], v[172:175], v[112:115]
    ds_read_b64_tr_b16 v[236:237], v241 offset:12288
    v_mfma_f32_16x16x32_bf16 v[112:115], v[208:211], v[168:171], v[112:115]
    ds_read_b64_tr_b16 v[238:239], v241 offset:12800
    s_waitcnt lgkmcnt(8)
    v_mfma_f32_16x16x32_bf16 v[116:119], v[216:219], v[168:171], v[116:119]
    ds_read_b64_tr_b16 v[208:209], v242 offset:0
    v_mfma_f32_16x16x32_bf16 v[116:119], v[220:223], v[172:175], v[116:119]
    ds_read_b64_tr_b16 v[210:211], v242 offset:512
    v_mfma_f32_16x16x32_bf16 v[84:87], v[220:223], v[164:167], v[84:87]
    ds_read_b64_tr_b16 v[212:213], v242 offset:4096
    v_mfma_f32_16x16x32_bf16 v[84:87], v[216:219], v[160:163], v[84:87]
    ds_read_b64_tr_b16 v[214:215], v242 offset:4608
    v_mfma_f32_16x16x32_bf16 v[52:55], v[216:219], v[152:155], v[52:55]
    v_mfma_f32_16x16x32_bf16 v[52:55], v[220:223], v[156:159], v[52:55]
    v_mfma_f32_16x16x32_bf16 v[20:23], v[220:223], v[148:151], v[20:23]
    v_mfma_f32_16x16x32_bf16 v[20:23], v[216:219], v[144:147], v[20:23]
    s_waitcnt lgkmcnt(8)
    v_mfma_f32_16x16x32_bf16 v[24:27], v[224:227], v[144:147], v[24:27]
    ds_read_b64_tr_b16 v[216:217], v242 offset:8192
    v_mfma_f32_16x16x32_bf16 v[24:27], v[228:231], v[148:151], v[24:27]
    ds_read_b64_tr_b16 v[218:219], v242 offset:8704
    v_mfma_f32_16x16x32_bf16 v[56:59], v[228:231], v[156:159], v[56:59]
    ds_read_b64_tr_b16 v[220:221], v242 offset:12288
    v_mfma_f32_16x16x32_bf16 v[56:59], v[224:227], v[152:155], v[56:59]
    ds_read_b64_tr_b16 v[222:223], v242 offset:12800
    v_mfma_f32_16x16x32_bf16 v[88:91], v[224:227], v[160:163], v[88:91]
    v_mfma_f32_16x16x32_bf16 v[88:91], v[228:231], v[164:167], v[88:91]
    v_mfma_f32_16x16x32_bf16 v[120:123], v[228:231], v[172:175], v[120:123]
    v_mfma_f32_16x16x32_bf16 v[120:123], v[224:227], v[168:171], v[120:123]
    s_waitcnt lgkmcnt(8)
    v_mfma_f32_16x16x32_bf16 v[124:127], v[232:235], v[168:171], v[124:127]
    ds_read_b64_tr_b16 v[224:225], v243 offset:0
    v_mfma_f32_16x16x32_bf16 v[124:127], v[236:239], v[172:175], v[124:127]
    ds_read_b64_tr_b16 v[226:227], v243 offset:512
    v_mfma_f32_16x16x32_bf16 v[92:95], v[236:239], v[164:167], v[92:95]
    ds_read_b64_tr_b16 v[228:229], v243 offset:4096
    v_mfma_f32_16x16x32_bf16 v[92:95], v[232:235], v[160:163], v[92:95]
    ds_read_b64_tr_b16 v[230:231], v243 offset:4608
    v_mfma_f32_16x16x32_bf16 v[60:63], v[232:235], v[152:155], v[60:63]
    v_mfma_f32_16x16x32_bf16 v[60:63], v[236:239], v[156:159], v[60:63]
    v_mfma_f32_16x16x32_bf16 v[28:31], v[236:239], v[148:151], v[28:31]
    v_mfma_f32_16x16x32_bf16 v[28:31], v[232:235], v[144:147], v[28:31]
    s_waitcnt lgkmcnt(8)
    v_mfma_f32_16x16x32_bf16 v[32:35], v[208:211], v[144:147], v[32:35]
    ds_read_b64_tr_b16 v[232:233], v243 offset:8192
    v_mfma_f32_16x16x32_bf16 v[32:35], v[212:215], v[148:151], v[32:35]
    ds_read_b64_tr_b16 v[234:235], v243 offset:8704
    v_mfma_f32_16x16x32_bf16 v[64:67], v[212:215], v[156:159], v[64:67]
    ds_read_b64_tr_b16 v[236:237], v243 offset:12288
    v_mfma_f32_16x16x32_bf16 v[64:67], v[208:211], v[152:155], v[64:67]
    ds_read_b64_tr_b16 v[238:239], v243 offset:12800
    v_mfma_f32_16x16x32_bf16 v[96:99], v[208:211], v[160:163], v[96:99]
    v_mfma_f32_16x16x32_bf16 v[96:99], v[212:215], v[164:167], v[96:99]
    v_mfma_f32_16x16x32_bf16 v[128:131], v[212:215], v[172:175], v[128:131]
    v_mfma_f32_16x16x32_bf16 v[128:131], v[208:211], v[168:171], v[128:131]
    s_waitcnt lgkmcnt(8)
    v_mfma_f32_16x16x32_bf16 v[132:135], v[216:219], v[168:171], v[132:135]
    v_mfma_f32_16x16x32_bf16 v[132:135], v[220:223], v[172:175], v[132:135]
    v_mfma_f32_16x16x32_bf16 v[100:103], v[220:223], v[164:167], v[100:103]
    v_mfma_f32_16x16x32_bf16 v[100:103], v[216:219], v[160:163], v[100:103]
    v_mfma_f32_16x16x32_bf16 v[68:71], v[216:219], v[152:155], v[68:71]
    v_mfma_f32_16x16x32_bf16 v[68:71], v[220:223], v[156:159], v[68:71]
    v_mfma_f32_16x16x32_bf16 v[36:39], v[220:223], v[148:151], v[36:39]
    v_mfma_f32_16x16x32_bf16 v[36:39], v[216:219], v[144:147], v[36:39]
    s_waitcnt lgkmcnt(0)
    s_barrier
    v_mfma_f32_16x16x32_bf16 v[40:43], v[224:227], v[144:147], v[40:43]
    ds_read_b128 v[176:179], v244 offset:32768
    v_mfma_f32_16x16x32_bf16 v[40:43], v[228:231], v[148:151], v[40:43]
    ds_read_b128 v[180:183], v245 offset:32768
    v_mfma_f32_16x16x32_bf16 v[72:75], v[228:231], v[156:159], v[72:75]
    ds_read_b64_tr_b16 v[208:209], v240 offset:16384
    v_mfma_f32_16x16x32_bf16 v[72:75], v[224:227], v[152:155], v[72:75]
    ds_read_b64_tr_b16 v[210:211], v240 offset:16896
    v_mfma_f32_16x16x32_bf16 v[104:107], v[224:227], v[160:163], v[104:107]
    ds_read_b64_tr_b16 v[212:213], v240 offset:20480
    v_mfma_f32_16x16x32_bf16 v[104:107], v[228:231], v[164:167], v[104:107]
    ds_read_b64_tr_b16 v[214:215], v240 offset:20992
    v_mfma_f32_16x16x32_bf16 v[136:139], v[228:231], v[172:175], v[136:139]
    ds_read_b128 v[184:187], v244 offset:34816
    v_mfma_f32_16x16x32_bf16 v[136:139], v[224:227], v[168:171], v[136:139]
    ds_read_b128 v[188:191], v245 offset:34816
    v_mfma_f32_16x16x32_bf16 v[140:143], v[232:235], v[168:171], v[140:143]
    ds_read_b128 v[192:195], v244 offset:49152
    v_mfma_f32_16x16x32_bf16 v[140:143], v[236:239], v[172:175], v[140:143]
    ds_read_b128 v[196:199], v245 offset:49152
    v_mfma_f32_16x16x32_bf16 v[108:111], v[236:239], v[164:167], v[108:111]
    ds_read_b128 v[200:203], v244 offset:51200
    v_mfma_f32_16x16x32_bf16 v[108:111], v[232:235], v[160:163], v[108:111]
    ds_read_b128 v[204:207], v245 offset:51200
    v_mfma_f32_16x16x32_bf16 v[76:79], v[232:235], v[152:155], v[76:79]
    ds_read_b64_tr_b16 v[216:217], v240 offset:24576
    v_mfma_f32_16x16x32_bf16 v[76:79], v[236:239], v[156:159], v[76:79]
    ds_read_b64_tr_b16 v[218:219], v240 offset:25088
    v_mfma_f32_16x16x32_bf16 v[44:47], v[236:239], v[148:151], v[44:47]
    ds_read_b64_tr_b16 v[220:221], v240 offset:28672
    v_mfma_f32_16x16x32_bf16 v[44:47], v[232:235], v[144:147], v[44:47]
    ds_read_b64_tr_b16 v[222:223], v240 offset:29184
    s_waitcnt lgkmcnt(10)
    v_mfma_f32_16x16x32_bf16 v[16:19], v[208:211], v[176:179], v[16:19]
    ds_read_b64_tr_b16 v[224:225], v241 offset:16384
    v_mfma_f32_16x16x32_bf16 v[16:19], v[212:215], v[180:183], v[16:19]
    ds_read_b64_tr_b16 v[226:227], v241 offset:16896
    s_waitcnt lgkmcnt(10)
    v_mfma_f32_16x16x32_bf16 v[48:51], v[212:215], v[188:191], v[48:51]
    ds_read_b64_tr_b16 v[228:229], v241 offset:20480
    v_mfma_f32_16x16x32_bf16 v[48:51], v[208:211], v[184:187], v[48:51]
    ds_read_b64_tr_b16 v[230:231], v241 offset:20992
    s_waitcnt lgkmcnt(10)
    v_mfma_f32_16x16x32_bf16 v[80:83], v[208:211], v[192:195], v[80:83]
    ds_read_b64_tr_b16 v[232:233], v241 offset:24576
    v_mfma_f32_16x16x32_bf16 v[80:83], v[212:215], v[196:199], v[80:83]
    ds_read_b64_tr_b16 v[234:235], v241 offset:25088
    s_waitcnt lgkmcnt(10)
    v_mfma_f32_16x16x32_bf16 v[112:115], v[212:215], v[204:207], v[112:115]
    ds_read_b64_tr_b16 v[236:237], v241 offset:28672
    v_mfma_f32_16x16x32_bf16 v[112:115], v[208:211], v[200:203], v[112:115]
    ds_read_b64_tr_b16 v[238:239], v241 offset:29184
    s_waitcnt lgkmcnt(8)
    v_mfma_f32_16x16x32_bf16 v[116:119], v[216:219], v[200:203], v[116:119]
    ds_read_b64_tr_b16 v[208:209], v242 offset:16384
    v_mfma_f32_16x16x32_bf16 v[116:119], v[220:223], v[204:207], v[116:119]
    ds_read_b64_tr_b16 v[210:211], v242 offset:16896
    v_mfma_f32_16x16x32_bf16 v[84:87], v[220:223], v[196:199], v[84:87]
    ds_read_b64_tr_b16 v[212:213], v242 offset:20480
    v_mfma_f32_16x16x32_bf16 v[84:87], v[216:219], v[192:195], v[84:87]
    ds_read_b64_tr_b16 v[214:215], v242 offset:20992
    v_mfma_f32_16x16x32_bf16 v[52:55], v[216:219], v[184:187], v[52:55]
    v_mfma_f32_16x16x32_bf16 v[52:55], v[220:223], v[188:191], v[52:55]
    v_mfma_f32_16x16x32_bf16 v[20:23], v[220:223], v[180:183], v[20:23]
    v_mfma_f32_16x16x32_bf16 v[20:23], v[216:219], v[176:179], v[20:23]
    s_waitcnt lgkmcnt(8)
    v_mfma_f32_16x16x32_bf16 v[24:27], v[224:227], v[176:179], v[24:27]
    ds_read_b64_tr_b16 v[216:217], v242 offset:24576
    v_mfma_f32_16x16x32_bf16 v[24:27], v[228:231], v[180:183], v[24:27]
    ds_read_b64_tr_b16 v[218:219], v242 offset:25088
    v_mfma_f32_16x16x32_bf16 v[56:59], v[228:231], v[188:191], v[56:59]
    ds_read_b64_tr_b16 v[220:221], v242 offset:28672
    v_mfma_f32_16x16x32_bf16 v[56:59], v[224:227], v[184:187], v[56:59]
    ds_read_b64_tr_b16 v[222:223], v242 offset:29184
    v_mfma_f32_16x16x32_bf16 v[88:91], v[224:227], v[192:195], v[88:91]
    v_mfma_f32_16x16x32_bf16 v[88:91], v[228:231], v[196:199], v[88:91]
    v_mfma_f32_16x16x32_bf16 v[120:123], v[228:231], v[204:207], v[120:123]
    v_mfma_f32_16x16x32_bf16 v[120:123], v[224:227], v[200:203], v[120:123]
    s_waitcnt lgkmcnt(8)
    v_mfma_f32_16x16x32_bf16 v[124:127], v[232:235], v[200:203], v[124:127]
    ds_read_b64_tr_b16 v[224:225], v243 offset:16384
    v_mfma_f32_16x16x32_bf16 v[124:127], v[236:239], v[204:207], v[124:127]
    ds_read_b64_tr_b16 v[226:227], v243 offset:16896
    v_mfma_f32_16x16x32_bf16 v[92:95], v[236:239], v[196:199], v[92:95]
    ds_read_b64_tr_b16 v[228:229], v243 offset:20480
    v_mfma_f32_16x16x32_bf16 v[92:95], v[232:235], v[192:195], v[92:95]
    ds_read_b64_tr_b16 v[230:231], v243 offset:20992
    v_mfma_f32_16x16x32_bf16 v[60:63], v[232:235], v[184:187], v[60:63]
    v_mfma_f32_16x16x32_bf16 v[60:63], v[236:239], v[188:191], v[60:63]
    v_mfma_f32_16x16x32_bf16 v[28:31], v[236:239], v[180:183], v[28:31]
    v_mfma_f32_16x16x32_bf16 v[28:31], v[232:235], v[176:179], v[28:31]
    s_waitcnt lgkmcnt(8)
    v_mfma_f32_16x16x32_bf16 v[32:35], v[208:211], v[176:179], v[32:35]
    ds_read_b64_tr_b16 v[232:233], v243 offset:24576
    v_mfma_f32_16x16x32_bf16 v[32:35], v[212:215], v[180:183], v[32:35]
    ds_read_b64_tr_b16 v[234:235], v243 offset:25088
    v_mfma_f32_16x16x32_bf16 v[64:67], v[212:215], v[188:191], v[64:67]
    ds_read_b64_tr_b16 v[236:237], v243 offset:28672
    v_mfma_f32_16x16x32_bf16 v[64:67], v[208:211], v[184:187], v[64:67]
    ds_read_b64_tr_b16 v[238:239], v243 offset:29184
    v_mfma_f32_16x16x32_bf16 v[96:99], v[208:211], v[192:195], v[96:99]
    v_mfma_f32_16x16x32_bf16 v[96:99], v[212:215], v[196:199], v[96:99]
    v_mfma_f32_16x16x32_bf16 v[128:131], v[212:215], v[204:207], v[128:131]
    v_mfma_f32_16x16x32_bf16 v[128:131], v[208:211], v[200:203], v[128:131]
    s_waitcnt lgkmcnt(8)
    v_mfma_f32_16x16x32_bf16 v[132:135], v[216:219], v[200:203], v[132:135]
    v_mfma_f32_16x16x32_bf16 v[132:135], v[220:223], v[204:207], v[132:135]
    v_mfma_f32_16x16x32_bf16 v[100:103], v[220:223], v[196:199], v[100:103]
    v_mfma_f32_16x16x32_bf16 v[100:103], v[216:219], v[192:195], v[100:103]
    v_mfma_f32_16x16x32_bf16 v[68:71], v[216:219], v[184:187], v[68:71]
    v_mfma_f32_16x16x32_bf16 v[68:71], v[220:223], v[188:191], v[68:71]
    v_mfma_f32_16x16x32_bf16 v[36:39], v[220:223], v[180:183], v[36:39]
    v_mfma_f32_16x16x32_bf16 v[36:39], v[216:219], v[176:179], v[36:39]
    s_waitcnt lgkmcnt(0)
    s_barrier
    v_mfma_f32_16x16x32_bf16 v[40:43], v[224:227], v[176:179], v[40:43]
    ds_read_b128 v[144:147], v244 offset:0
    v_mfma_f32_16x16x32_bf16 v[40:43], v[228:231], v[180:183], v[40:43]
    ds_read_b128 v[148:151], v245 offset:0
    v_mfma_f32_16x16x32_bf16 v[72:75], v[228:231], v[188:191], v[72:75]
    ds_read_b64_tr_b16 v[208:209], v240 offset:32768
    v_mfma_f32_16x16x32_bf16 v[72:75], v[224:227], v[184:187], v[72:75]
    ds_read_b64_tr_b16 v[210:211], v240 offset:33280
    v_mfma_f32_16x16x32_bf16 v[104:107], v[224:227], v[192:195], v[104:107]
    ds_read_b64_tr_b16 v[212:213], v240 offset:36864
    v_mfma_f32_16x16x32_bf16 v[104:107], v[228:231], v[196:199], v[104:107]
    ds_read_b64_tr_b16 v[214:215], v240 offset:37376
    v_mfma_f32_16x16x32_bf16 v[136:139], v[228:231], v[204:207], v[136:139]
    ds_read_b128 v[152:155], v244 offset:2048
    v_mfma_f32_16x16x32_bf16 v[136:139], v[224:227], v[200:203], v[136:139]
    ds_read_b128 v[156:159], v245 offset:2048
    v_mfma_f32_16x16x32_bf16 v[140:143], v[232:235], v[200:203], v[140:143]
    ds_read_b128 v[160:163], v244 offset:16384
    v_mfma_f32_16x16x32_bf16 v[140:143], v[236:239], v[204:207], v[140:143]
    ds_read_b128 v[164:167], v245 offset:16384
    v_mfma_f32_16x16x32_bf16 v[108:111], v[236:239], v[196:199], v[108:111]
    ds_read_b128 v[168:171], v244 offset:18432
    v_mfma_f32_16x16x32_bf16 v[108:111], v[232:235], v[192:195], v[108:111]
    ds_read_b128 v[172:175], v245 offset:18432
    v_mfma_f32_16x16x32_bf16 v[76:79], v[232:235], v[184:187], v[76:79]
    ds_read_b64_tr_b16 v[216:217], v240 offset:40960
    v_mfma_f32_16x16x32_bf16 v[76:79], v[236:239], v[188:191], v[76:79]
    ds_read_b64_tr_b16 v[218:219], v240 offset:41472
    v_mfma_f32_16x16x32_bf16 v[44:47], v[236:239], v[180:183], v[44:47]
    ds_read_b64_tr_b16 v[220:221], v240 offset:45056
    v_mfma_f32_16x16x32_bf16 v[44:47], v[232:235], v[176:179], v[44:47]
    ds_read_b64_tr_b16 v[222:223], v240 offset:45568
    s_waitcnt lgkmcnt(10)
    v_mfma_f32_16x16x32_bf16 v[16:19], v[208:211], v[144:147], v[16:19]
    ds_read_b64_tr_b16 v[224:225], v241 offset:32768
    v_mfma_f32_16x16x32_bf16 v[16:19], v[212:215], v[148:151], v[16:19]
    ds_read_b64_tr_b16 v[226:227], v241 offset:33280
    s_waitcnt lgkmcnt(10)
    v_mfma_f32_16x16x32_bf16 v[48:51], v[212:215], v[156:159], v[48:51]
    ds_read_b64_tr_b16 v[228:229], v241 offset:36864
    v_mfma_f32_16x16x32_bf16 v[48:51], v[208:211], v[152:155], v[48:51]
    ds_read_b64_tr_b16 v[230:231], v241 offset:37376
    s_waitcnt lgkmcnt(10)
    v_mfma_f32_16x16x32_bf16 v[80:83], v[208:211], v[160:163], v[80:83]
    ds_read_b64_tr_b16 v[232:233], v241 offset:40960
    v_mfma_f32_16x16x32_bf16 v[80:83], v[212:215], v[164:167], v[80:83]
    ds_read_b64_tr_b16 v[234:235], v241 offset:41472
    s_waitcnt lgkmcnt(10)
    v_mfma_f32_16x16x32_bf16 v[112:115], v[212:215], v[172:175], v[112:115]
    ds_read_b64_tr_b16 v[236:237], v241 offset:45056
    v_mfma_f32_16x16x32_bf16 v[112:115], v[208:211], v[168:171], v[112:115]
    ds_read_b64_tr_b16 v[238:239], v241 offset:45568
    s_waitcnt lgkmcnt(8)
    v_mfma_f32_16x16x32_bf16 v[116:119], v[216:219], v[168:171], v[116:119]
    ds_read_b64_tr_b16 v[208:209], v242 offset:32768
    v_mfma_f32_16x16x32_bf16 v[116:119], v[220:223], v[172:175], v[116:119]
    ds_read_b64_tr_b16 v[210:211], v242 offset:33280
    v_mfma_f32_16x16x32_bf16 v[84:87], v[220:223], v[164:167], v[84:87]
    ds_read_b64_tr_b16 v[212:213], v242 offset:36864
    v_mfma_f32_16x16x32_bf16 v[84:87], v[216:219], v[160:163], v[84:87]
    ds_read_b64_tr_b16 v[214:215], v242 offset:37376
    v_mfma_f32_16x16x32_bf16 v[52:55], v[216:219], v[152:155], v[52:55]
    v_mfma_f32_16x16x32_bf16 v[52:55], v[220:223], v[156:159], v[52:55]
    v_mfma_f32_16x16x32_bf16 v[20:23], v[220:223], v[148:151], v[20:23]
    v_mfma_f32_16x16x32_bf16 v[20:23], v[216:219], v[144:147], v[20:23]
    s_waitcnt lgkmcnt(8)
    v_mfma_f32_16x16x32_bf16 v[24:27], v[224:227], v[144:147], v[24:27]
    ds_read_b64_tr_b16 v[216:217], v242 offset:40960
    v_mfma_f32_16x16x32_bf16 v[24:27], v[228:231], v[148:151], v[24:27]
    ds_read_b64_tr_b16 v[218:219], v242 offset:41472
    v_mfma_f32_16x16x32_bf16 v[56:59], v[228:231], v[156:159], v[56:59]
    ds_read_b64_tr_b16 v[220:221], v242 offset:45056
    v_mfma_f32_16x16x32_bf16 v[56:59], v[224:227], v[152:155], v[56:59]
    ds_read_b64_tr_b16 v[222:223], v242 offset:45568
    v_mfma_f32_16x16x32_bf16 v[88:91], v[224:227], v[160:163], v[88:91]
    v_mfma_f32_16x16x32_bf16 v[88:91], v[228:231], v[164:167], v[88:91]
    v_mfma_f32_16x16x32_bf16 v[120:123], v[228:231], v[172:175], v[120:123]
    v_mfma_f32_16x16x32_bf16 v[120:123], v[224:227], v[168:171], v[120:123]
    s_waitcnt lgkmcnt(8)
    v_mfma_f32_16x16x32_bf16 v[124:127], v[232:235], v[168:171], v[124:127]
    ds_read_b64_tr_b16 v[224:225], v243 offset:32768
    v_mfma_f32_16x16x32_bf16 v[124:127], v[236:239], v[172:175], v[124:127]
    ds_read_b64_tr_b16 v[226:227], v243 offset:33280
    v_mfma_f32_16x16x32_bf16 v[92:95], v[236:239], v[164:167], v[92:95]
    ds_read_b64_tr_b16 v[228:229], v243 offset:36864
    v_mfma_f32_16x16x32_bf16 v[92:95], v[232:235], v[160:163], v[92:95]
    ds_read_b64_tr_b16 v[230:231], v243 offset:37376
    v_mfma_f32_16x16x32_bf16 v[60:63], v[232:235], v[152:155], v[60:63]
    v_mfma_f32_16x16x32_bf16 v[60:63], v[236:239], v[156:159], v[60:63]
    v_mfma_f32_16x16x32_bf16 v[28:31], v[236:239], v[148:151], v[28:31]
    v_mfma_f32_16x16x32_bf16 v[28:31], v[232:235], v[144:147], v[28:31]
    s_waitcnt lgkmcnt(8)
    v_mfma_f32_16x16x32_bf16 v[32:35], v[208:211], v[144:147], v[32:35]
    ds_read_b64_tr_b16 v[232:233], v243 offset:40960
    v_mfma_f32_16x16x32_bf16 v[32:35], v[212:215], v[148:151], v[32:35]
    ds_read_b64_tr_b16 v[234:235], v243 offset:41472
    v_mfma_f32_16x16x32_bf16 v[64:67], v[212:215], v[156:159], v[64:67]
    ds_read_b64_tr_b16 v[236:237], v243 offset:45056
    v_mfma_f32_16x16x32_bf16 v[64:67], v[208:211], v[152:155], v[64:67]
    ds_read_b64_tr_b16 v[238:239], v243 offset:45568
    v_mfma_f32_16x16x32_bf16 v[96:99], v[208:211], v[160:163], v[96:99]
    v_mfma_f32_16x16x32_bf16 v[96:99], v[212:215], v[164:167], v[96:99]
    v_mfma_f32_16x16x32_bf16 v[128:131], v[212:215], v[172:175], v[128:131]
    v_mfma_f32_16x16x32_bf16 v[128:131], v[208:211], v[168:171], v[128:131]
    s_waitcnt lgkmcnt(8)
    v_mfma_f32_16x16x32_bf16 v[132:135], v[216:219], v[168:171], v[132:135]
    v_mfma_f32_16x16x32_bf16 v[132:135], v[220:223], v[172:175], v[132:135]
    v_mfma_f32_16x16x32_bf16 v[100:103], v[220:223], v[164:167], v[100:103]
    v_mfma_f32_16x16x32_bf16 v[100:103], v[216:219], v[160:163], v[100:103]
    v_mfma_f32_16x16x32_bf16 v[68:71], v[216:219], v[152:155], v[68:71]
    v_mfma_f32_16x16x32_bf16 v[68:71], v[220:223], v[156:159], v[68:71]
    v_mfma_f32_16x16x32_bf16 v[36:39], v[220:223], v[148:151], v[36:39]
    v_mfma_f32_16x16x32_bf16 v[36:39], v[216:219], v[144:147], v[36:39]
    s_waitcnt lgkmcnt(0)
    s_barrier
    v_mfma_f32_16x16x32_bf16 v[40:43], v[224:227], v[144:147], v[40:43]
    ds_read_b128 v[176:179], v246 offset:0
    v_mfma_f32_16x16x32_bf16 v[40:43], v[228:231], v[148:151], v[40:43]
    ds_read_b128 v[180:183], v247 offset:0
    v_mfma_f32_16x16x32_bf16 v[72:75], v[228:231], v[156:159], v[72:75]
    ds_read_b64_tr_b16 v[208:209], v240 offset:49152
    v_mfma_f32_16x16x32_bf16 v[72:75], v[224:227], v[152:155], v[72:75]
    ds_read_b64_tr_b16 v[210:211], v240 offset:49664
    v_mfma_f32_16x16x32_bf16 v[104:107], v[224:227], v[160:163], v[104:107]
    ds_read_b64_tr_b16 v[212:213], v240 offset:53248
    v_mfma_f32_16x16x32_bf16 v[104:107], v[228:231], v[164:167], v[104:107]
    ds_read_b64_tr_b16 v[214:215], v240 offset:53760
    v_mfma_f32_16x16x32_bf16 v[136:139], v[228:231], v[172:175], v[136:139]
    ds_read_b128 v[184:187], v246 offset:2048
    v_mfma_f32_16x16x32_bf16 v[136:139], v[224:227], v[168:171], v[136:139]
    ds_read_b128 v[188:191], v247 offset:2048
    v_mfma_f32_16x16x32_bf16 v[140:143], v[232:235], v[168:171], v[140:143]
    ds_read_b128 v[192:195], v246 offset:16384
    v_mfma_f32_16x16x32_bf16 v[140:143], v[236:239], v[172:175], v[140:143]
    ds_read_b128 v[196:199], v247 offset:16384
    v_mfma_f32_16x16x32_bf16 v[108:111], v[236:239], v[164:167], v[108:111]
    ds_read_b128 v[200:203], v246 offset:18432
    v_mfma_f32_16x16x32_bf16 v[108:111], v[232:235], v[160:163], v[108:111]
    ds_read_b128 v[204:207], v247 offset:18432
    v_mfma_f32_16x16x32_bf16 v[76:79], v[232:235], v[152:155], v[76:79]
    ds_read_b64_tr_b16 v[216:217], v240 offset:57344
    v_mfma_f32_16x16x32_bf16 v[76:79], v[236:239], v[156:159], v[76:79]
    ds_read_b64_tr_b16 v[218:219], v240 offset:57856
    v_mfma_f32_16x16x32_bf16 v[44:47], v[236:239], v[148:151], v[44:47]
    ds_read_b64_tr_b16 v[220:221], v240 offset:61440
    v_mfma_f32_16x16x32_bf16 v[44:47], v[232:235], v[144:147], v[44:47]
    ds_read_b64_tr_b16 v[222:223], v240 offset:61952
    s_waitcnt lgkmcnt(10)
    v_mfma_f32_16x16x32_bf16 v[16:19], v[208:211], v[176:179], v[16:19]
    ds_read_b64_tr_b16 v[224:225], v241 offset:49152
    v_mfma_f32_16x16x32_bf16 v[16:19], v[212:215], v[180:183], v[16:19]
    ds_read_b64_tr_b16 v[226:227], v241 offset:49664
    s_waitcnt lgkmcnt(10)
    v_mfma_f32_16x16x32_bf16 v[48:51], v[212:215], v[188:191], v[48:51]
    ds_read_b64_tr_b16 v[228:229], v241 offset:53248
    v_mfma_f32_16x16x32_bf16 v[48:51], v[208:211], v[184:187], v[48:51]
    ds_read_b64_tr_b16 v[230:231], v241 offset:53760
    s_waitcnt lgkmcnt(10)
    v_mfma_f32_16x16x32_bf16 v[80:83], v[208:211], v[192:195], v[80:83]
    ds_read_b64_tr_b16 v[232:233], v241 offset:57344
    v_mfma_f32_16x16x32_bf16 v[80:83], v[212:215], v[196:199], v[80:83]
    ds_read_b64_tr_b16 v[234:235], v241 offset:57856
    s_waitcnt lgkmcnt(10)
    v_mfma_f32_16x16x32_bf16 v[112:115], v[212:215], v[204:207], v[112:115]
    ds_read_b64_tr_b16 v[236:237], v241 offset:61440
    v_mfma_f32_16x16x32_bf16 v[112:115], v[208:211], v[200:203], v[112:115]
    ds_read_b64_tr_b16 v[238:239], v241 offset:61952
    s_waitcnt lgkmcnt(8)
    v_mfma_f32_16x16x32_bf16 v[116:119], v[216:219], v[200:203], v[116:119]
    ds_read_b64_tr_b16 v[208:209], v242 offset:49152
    v_mfma_f32_16x16x32_bf16 v[116:119], v[220:223], v[204:207], v[116:119]
    ds_read_b64_tr_b16 v[210:211], v242 offset:49664
    v_mfma_f32_16x16x32_bf16 v[84:87], v[220:223], v[196:199], v[84:87]
    ds_read_b64_tr_b16 v[212:213], v242 offset:53248
    v_mfma_f32_16x16x32_bf16 v[84:87], v[216:219], v[192:195], v[84:87]
    ds_read_b64_tr_b16 v[214:215], v242 offset:53760
    v_mfma_f32_16x16x32_bf16 v[52:55], v[216:219], v[184:187], v[52:55]
    v_mfma_f32_16x16x32_bf16 v[52:55], v[220:223], v[188:191], v[52:55]
    v_mfma_f32_16x16x32_bf16 v[20:23], v[220:223], v[180:183], v[20:23]
    v_mfma_f32_16x16x32_bf16 v[20:23], v[216:219], v[176:179], v[20:23]
    s_waitcnt lgkmcnt(8)
    v_mfma_f32_16x16x32_bf16 v[24:27], v[224:227], v[176:179], v[24:27]
    ds_read_b64_tr_b16 v[216:217], v242 offset:57344
    v_mfma_f32_16x16x32_bf16 v[24:27], v[228:231], v[180:183], v[24:27]
    ds_read_b64_tr_b16 v[218:219], v242 offset:57856
    v_mfma_f32_16x16x32_bf16 v[56:59], v[228:231], v[188:191], v[56:59]
    ds_read_b64_tr_b16 v[220:221], v242 offset:61440
    v_mfma_f32_16x16x32_bf16 v[56:59], v[224:227], v[184:187], v[56:59]
    ds_read_b64_tr_b16 v[222:223], v242 offset:61952
    v_mfma_f32_16x16x32_bf16 v[88:91], v[224:227], v[192:195], v[88:91]
    v_mfma_f32_16x16x32_bf16 v[88:91], v[228:231], v[196:199], v[88:91]
    v_mfma_f32_16x16x32_bf16 v[120:123], v[228:231], v[204:207], v[120:123]
    v_mfma_f32_16x16x32_bf16 v[120:123], v[224:227], v[200:203], v[120:123]
    s_waitcnt lgkmcnt(8)
    v_mfma_f32_16x16x32_bf16 v[124:127], v[232:235], v[200:203], v[124:127]
    ds_read_b64_tr_b16 v[224:225], v243 offset:49152
    v_mfma_f32_16x16x32_bf16 v[124:127], v[236:239], v[204:207], v[124:127]
    ds_read_b64_tr_b16 v[226:227], v243 offset:49664
    v_mfma_f32_16x16x32_bf16 v[92:95], v[236:239], v[196:199], v[92:95]
    ds_read_b64_tr_b16 v[228:229], v243 offset:53248
    v_mfma_f32_16x16x32_bf16 v[92:95], v[232:235], v[192:195], v[92:95]
    ds_read_b64_tr_b16 v[230:231], v243 offset:53760
    v_mfma_f32_16x16x32_bf16 v[60:63], v[232:235], v[184:187], v[60:63]
    v_mfma_f32_16x16x32_bf16 v[60:63], v[236:239], v[188:191], v[60:63]
    v_mfma_f32_16x16x32_bf16 v[28:31], v[236:239], v[180:183], v[28:31]
    v_mfma_f32_16x16x32_bf16 v[28:31], v[232:235], v[176:179], v[28:31]
    s_waitcnt lgkmcnt(8)
    v_mfma_f32_16x16x32_bf16 v[32:35], v[208:211], v[176:179], v[32:35]
    ds_read_b64_tr_b16 v[232:233], v243 offset:57344
    v_mfma_f32_16x16x32_bf16 v[32:35], v[212:215], v[180:183], v[32:35]
    ds_read_b64_tr_b16 v[234:235], v243 offset:57856
    v_mfma_f32_16x16x32_bf16 v[64:67], v[212:215], v[188:191], v[64:67]
    ds_read_b64_tr_b16 v[236:237], v243 offset:61440
    v_mfma_f32_16x16x32_bf16 v[64:67], v[208:211], v[184:187], v[64:67]
    ds_read_b64_tr_b16 v[238:239], v243 offset:61952
    v_mfma_f32_16x16x32_bf16 v[96:99], v[208:211], v[192:195], v[96:99]
    v_mfma_f32_16x16x32_bf16 v[96:99], v[212:215], v[196:199], v[96:99]
    v_mfma_f32_16x16x32_bf16 v[128:131], v[212:215], v[204:207], v[128:131]
    v_mfma_f32_16x16x32_bf16 v[128:131], v[208:211], v[200:203], v[128:131]
    s_waitcnt lgkmcnt(8)
    v_mfma_f32_16x16x32_bf16 v[132:135], v[216:219], v[200:203], v[132:135]
    v_mfma_f32_16x16x32_bf16 v[132:135], v[220:223], v[204:207], v[132:135]
    v_mfma_f32_16x16x32_bf16 v[100:103], v[220:223], v[196:199], v[100:103]
    v_mfma_f32_16x16x32_bf16 v[100:103], v[216:219], v[192:195], v[100:103]
    v_mfma_f32_16x16x32_bf16 v[68:71], v[216:219], v[184:187], v[68:71]
    v_mfma_f32_16x16x32_bf16 v[68:71], v[220:223], v[188:191], v[68:71]
    v_mfma_f32_16x16x32_bf16 v[36:39], v[220:223], v[180:183], v[36:39]
    v_mfma_f32_16x16x32_bf16 v[36:39], v[216:219], v[176:179], v[36:39]
    s_waitcnt lgkmcnt(4)
    v_mfma_f32_16x16x32_bf16 v[40:43], v[224:227], v[176:179], v[40:43]
    v_mfma_f32_16x16x32_bf16 v[40:43], v[228:231], v[180:183], v[40:43]
    v_mfma_f32_16x16x32_bf16 v[72:75], v[228:231], v[188:191], v[72:75]
    v_mfma_f32_16x16x32_bf16 v[72:75], v[224:227], v[184:187], v[72:75]
    v_mfma_f32_16x16x32_bf16 v[104:107], v[224:227], v[192:195], v[104:107]
    v_mfma_f32_16x16x32_bf16 v[104:107], v[228:231], v[196:199], v[104:107]
    v_mfma_f32_16x16x32_bf16 v[136:139], v[228:231], v[204:207], v[136:139]
    v_mfma_f32_16x16x32_bf16 v[136:139], v[224:227], v[200:203], v[136:139]
    s_waitcnt lgkmcnt(0)
    v_mfma_f32_16x16x32_bf16 v[140:143], v[232:235], v[200:203], v[140:143]
    v_mfma_f32_16x16x32_bf16 v[140:143], v[236:239], v[204:207], v[140:143]
    v_mfma_f32_16x16x32_bf16 v[108:111], v[236:239], v[196:199], v[108:111]
    v_mfma_f32_16x16x32_bf16 v[108:111], v[232:235], v[192:195], v[108:111]
    v_mfma_f32_16x16x32_bf16 v[76:79], v[232:235], v[184:187], v[76:79]
    v_mfma_f32_16x16x32_bf16 v[76:79], v[236:239], v[188:191], v[76:79]
    v_mfma_f32_16x16x32_bf16 v[44:47], v[236:239], v[180:183], v[44:47]
    v_mfma_f32_16x16x32_bf16 v[44:47], v[232:235], v[176:179], v[44:47]
    v_pk_fma_f32 v[144:145], v[16:17], v[16:17], v[248:249] op_sel_hi:[1,1,0]
    v_pk_fma_f32 v[146:147], v[18:19], v[18:19], v[248:249] op_sel_hi:[1,1,0]
    v_pk_fma_f32 v[148:149], v[24:25], v[24:25], v[248:249] op_sel_hi:[1,1,0]
    v_pk_fma_f32 v[150:151], v[26:27], v[26:27], v[248:249] op_sel_hi:[1,1,0]
    v_pk_mul_f32 v[144:145], v[144:145], v[16:17] neg_lo:[0,1] neg_hi:[0,1]
    v_pk_mul_f32 v[146:147], v[146:147], v[18:19] neg_lo:[0,1] neg_hi:[0,1]
    v_pk_mul_f32 v[148:149], v[148:149], v[24:25] neg_lo:[0,1] neg_hi:[0,1]
    v_pk_mul_f32 v[150:151], v[150:151], v[26:27] neg_lo:[0,1] neg_hi:[0,1]
    v_exp_f32 v144, v144
    v_exp_f32 v145, v145
    v_exp_f32 v146, v146
    v_exp_f32 v147, v147
    v_exp_f32 v148, v148
    v_exp_f32 v149, v149
    v_exp_f32 v150, v150
    v_exp_f32 v151, v151
    v_pk_mul_f32 v[20:21], v[20:21], v[16:17]
    v_pk_mul_f32 v[22:23], v[22:23], v[18:19]
    v_pk_mul_f32 v[28:29], v[28:29], v[24:25]
    v_pk_mul_f32 v[30:31], v[30:31], v[26:27]
    v_pk_add_f32 v[144:145], v[144:145], 1.0 op_sel_hi:[1,0]
    v_pk_add_f32 v[146:147], v[146:147], 1.0 op_sel_hi:[1,0]
    v_pk_add_f32 v[148:149], v[148:149], 1.0 op_sel_hi:[1,0]
    v_pk_add_f32 v[150:151], v[150:151], 1.0 op_sel_hi:[1,0]
    v_rcp_f32 v144, v144
    v_rcp_f32 v145, v145
    v_rcp_f32 v146, v146
    v_rcp_f32 v147, v147
    v_rcp_f32 v148, v148
    v_rcp_f32 v149, v149
    v_rcp_f32 v150, v150
    v_rcp_f32 v151, v151
    v_pk_mul_f32 v[20:21], v[20:21], v[144:145]
    v_pk_mul_f32 v[22:23], v[22:23], v[146:147]
    v_pk_mul_f32 v[28:29], v[28:29], v[148:149]
    v_pk_mul_f32 v[30:31], v[30:31], v[150:151]
    v_cvt_pk_bf16_f32 v16, v20, v21
    v_cvt_pk_bf16_f32 v17, v22, v23
    v_cvt_pk_bf16_f32 v18, v28, v29
    v_cvt_pk_bf16_f32 v19, v30, v31
    s_add_u32 s75, s76, 0
    buffer_store_dwordx4 v[16:19], v6, s[64:67], s75 offen offset:0 sc1
    v_pk_fma_f32 v[144:145], v[32:33], v[32:33], v[248:249] op_sel_hi:[1,1,0]
    v_pk_fma_f32 v[146:147], v[34:35], v[34:35], v[248:249] op_sel_hi:[1,1,0]
    v_pk_fma_f32 v[148:149], v[40:41], v[40:41], v[248:249] op_sel_hi:[1,1,0]
    v_pk_fma_f32 v[150:151], v[42:43], v[42:43], v[248:249] op_sel_hi:[1,1,0]
    v_pk_mul_f32 v[144:145], v[144:145], v[32:33] neg_lo:[0,1] neg_hi:[0,1]
    v_pk_mul_f32 v[146:147], v[146:147], v[34:35] neg_lo:[0,1] neg_hi:[0,1]
    v_pk_mul_f32 v[148:149], v[148:149], v[40:41] neg_lo:[0,1] neg_hi:[0,1]
    v_pk_mul_f32 v[150:151], v[150:151], v[42:43] neg_lo:[0,1] neg_hi:[0,1]
    v_exp_f32 v144, v144
    v_exp_f32 v145, v145
    v_exp_f32 v146, v146
    v_exp_f32 v147, v147
    v_exp_f32 v148, v148
    v_exp_f32 v149, v149
    v_exp_f32 v150, v150
    v_exp_f32 v151, v151
    v_pk_mul_f32 v[36:37], v[36:37], v[32:33]
    v_pk_mul_f32 v[38:39], v[38:39], v[34:35]
    v_pk_mul_f32 v[44:45], v[44:45], v[40:41]
    v_pk_mul_f32 v[46:47], v[46:47], v[42:43]
    v_pk_add_f32 v[144:145], v[144:145], 1.0 op_sel_hi:[1,0]
    v_pk_add_f32 v[146:147], v[146:147], 1.0 op_sel_hi:[1,0]
    v_pk_add_f32 v[148:149], v[148:149], 1.0 op_sel_hi:[1,0]
    v_pk_add_f32 v[150:151], v[150:151], 1.0 op_sel_hi:[1,0]
    v_rcp_f32 v144, v144
    v_rcp_f32 v145, v145
    v_rcp_f32 v146, v146
    v_rcp_f32 v147, v147
    v_rcp_f32 v148, v148
    v_rcp_f32 v149, v149
    v_rcp_f32 v150, v150
    v_rcp_f32 v151, v151
    v_pk_mul_f32 v[36:37], v[36:37], v[144:145]
    v_pk_mul_f32 v[38:39], v[38:39], v[146:147]
    v_pk_mul_f32 v[44:45], v[44:45], v[148:149]
    v_pk_mul_f32 v[46:47], v[46:47], v[150:151]
    v_cvt_pk_bf16_f32 v32, v36, v37
    v_cvt_pk_bf16_f32 v33, v38, v39
    v_cvt_pk_bf16_f32 v34, v44, v45
    v_cvt_pk_bf16_f32 v35, v46, v47
    s_add_u32 s75, s76, 0
    buffer_store_dwordx4 v[32:35], v6, s[64:67], s75 offen offset:1024 sc1
    v_pk_fma_f32 v[144:145], v[48:49], v[48:49], v[248:249] op_sel_hi:[1,1,0]
    v_pk_fma_f32 v[146:147], v[50:51], v[50:51], v[248:249] op_sel_hi:[1,1,0]
    v_pk_fma_f32 v[148:149], v[56:57], v[56:57], v[248:249] op_sel_hi:[1,1,0]
    v_pk_fma_f32 v[150:151], v[58:59], v[58:59], v[248:249] op_sel_hi:[1,1,0]
    v_pk_mul_f32 v[144:145], v[144:145], v[48:49] neg_lo:[0,1] neg_hi:[0,1]
    v_pk_mul_f32 v[146:147], v[146:147], v[50:51] neg_lo:[0,1] neg_hi:[0,1]
    v_pk_mul_f32 v[148:149], v[148:149], v[56:57] neg_lo:[0,1] neg_hi:[0,1]
    v_pk_mul_f32 v[150:151], v[150:151], v[58:59] neg_lo:[0,1] neg_hi:[0,1]
    v_exp_f32 v144, v144
    v_exp_f32 v145, v145
    v_exp_f32 v146, v146
    v_exp_f32 v147, v147
    v_exp_f32 v148, v148
    v_exp_f32 v149, v149
    v_exp_f32 v150, v150
    v_exp_f32 v151, v151
    v_pk_mul_f32 v[52:53], v[52:53], v[48:49]
    v_pk_mul_f32 v[54:55], v[54:55], v[50:51]
    v_pk_mul_f32 v[60:61], v[60:61], v[56:57]
    v_pk_mul_f32 v[62:63], v[62:63], v[58:59]
    v_pk_add_f32 v[144:145], v[144:145], 1.0 op_sel_hi:[1,0]
    v_pk_add_f32 v[146:147], v[146:147], 1.0 op_sel_hi:[1,0]
    v_pk_add_f32 v[148:149], v[148:149], 1.0 op_sel_hi:[1,0]
    v_pk_add_f32 v[150:151], v[150:151], 1.0 op_sel_hi:[1,0]
    v_rcp_f32 v144, v144
    v_rcp_f32 v145, v145
    v_rcp_f32 v146, v146
    v_rcp_f32 v147, v147
    v_rcp_f32 v148, v148
    v_rcp_f32 v149, v149
    v_rcp_f32 v150, v150
    v_rcp_f32 v151, v151
    v_pk_mul_f32 v[52:53], v[52:53], v[144:145]
    v_pk_mul_f32 v[54:55], v[54:55], v[146:147]
    v_pk_mul_f32 v[60:61], v[60:61], v[148:149]
    v_pk_mul_f32 v[62:63], v[62:63], v[150:151]
    v_cvt_pk_bf16_f32 v48, v52, v53
    v_cvt_pk_bf16_f32 v49, v54, v55
    v_cvt_pk_bf16_f32 v50, v60, v61
    v_cvt_pk_bf16_f32 v51, v62, v63
    s_add_u32 s75, s76, 57344
    buffer_store_dwordx4 v[48:51], v6, s[64:67], s75 offen offset:0 sc1
    v_pk_fma_f32 v[144:145], v[64:65], v[64:65], v[248:249] op_sel_hi:[1,1,0]
    v_pk_fma_f32 v[146:147], v[66:67], v[66:67], v[248:249] op_sel_hi:[1,1,0]
    v_pk_fma_f32 v[148:149], v[72:73], v[72:73], v[248:249] op_sel_hi:[1,1,0]
    v_pk_fma_f32 v[150:151], v[74:75], v[74:75], v[248:249] op_sel_hi:[1,1,0]
    v_pk_mul_f32 v[144:145], v[144:145], v[64:65] neg_lo:[0,1] neg_hi:[0,1]
    v_pk_mul_f32 v[146:147], v[146:147], v[66:67] neg_lo:[0,1] neg_hi:[0,1]
    v_pk_mul_f32 v[148:149], v[148:149], v[72:73] neg_lo:[0,1] neg_hi:[0,1]
    v_pk_mul_f32 v[150:151], v[150:151], v[74:75] neg_lo:[0,1] neg_hi:[0,1]
    v_exp_f32 v144, v144
    v_exp_f32 v145, v145
    v_exp_f32 v146, v146
    v_exp_f32 v147, v147
    v_exp_f32 v148, v148
    v_exp_f32 v149, v149
    v_exp_f32 v150, v150
    v_exp_f32 v151, v151
    v_pk_mul_f32 v[68:69], v[68:69], v[64:65]
    v_pk_mul_f32 v[70:71], v[70:71], v[66:67]
    v_pk_mul_f32 v[76:77], v[76:77], v[72:73]
    v_pk_mul_f32 v[78:79], v[78:79], v[74:75]
    v_pk_add_f32 v[144:145], v[144:145], 1.0 op_sel_hi:[1,0]
    v_pk_add_f32 v[146:147], v[146:147], 1.0 op_sel_hi:[1,0]
    v_pk_add_f32 v[148:149], v[148:149], 1.0 op_sel_hi:[1,0]
    v_pk_add_f32 v[150:151], v[150:151], 1.0 op_sel_hi:[1,0]
    v_rcp_f32 v144, v144
    v_rcp_f32 v145, v145
    v_rcp_f32 v146, v146
    v_rcp_f32 v147, v147
    v_rcp_f32 v148, v148
    v_rcp_f32 v149, v149
    v_rcp_f32 v150, v150
    v_rcp_f32 v151, v151
    v_pk_mul_f32 v[68:69], v[68:69], v[144:145]
    v_pk_mul_f32 v[70:71], v[70:71], v[146:147]
    v_pk_mul_f32 v[76:77], v[76:77], v[148:149]
    v_pk_mul_f32 v[78:79], v[78:79], v[150:151]
    v_cvt_pk_bf16_f32 v64, v68, v69
    v_cvt_pk_bf16_f32 v65, v70, v71
    v_cvt_pk_bf16_f32 v66, v76, v77
    v_cvt_pk_bf16_f32 v67, v78, v79
    s_waitcnt vmcnt(1)
    s_mov_b64 exec, 1
    s_cmp_eq_u32 s40, 0
    s_cbranch_scc1 slow_61
    buffer_store_dword v251, v250, s[64:67], s10 offen
    s_branch join_62
slow_61:
    buffer_store_dword v251, v250, s[64:67], s10 offen sc1
join_62:
    s_mov_b64 exec, -1
    s_barrier
    s_add_u32 s75, s76, 57344
    buffer_store_dwordx4 v[64:67], v6, s[64:67], s75 offen offset:1024 sc1
    v_pk_fma_f32 v[144:145], v[80:81], v[80:81], v[248:249] op_sel_hi:[1,1,0]
    v_pk_fma_f32 v[146:147], v[82:83], v[82:83], v[248:249] op_sel_hi:[1,1,0]
    v_pk_fma_f32 v[148:149], v[88:89], v[88:89], v[248:249] op_sel_hi:[1,1,0]
    v_pk_fma_f32 v[150:151], v[90:91], v[90:91], v[248:249] op_sel_hi:[1,1,0]
    v_pk_mul_f32 v[144:145], v[144:145], v[80:81] neg_lo:[0,1] neg_hi:[0,1]
    v_pk_mul_f32 v[146:147], v[146:147], v[82:83] neg_lo:[0,1] neg_hi:[0,1]
    v_pk_mul_f32 v[148:149], v[148:149], v[88:89] neg_lo:[0,1] neg_hi:[0,1]
    v_pk_mul_f32 v[150:151], v[150:151], v[90:91] neg_lo:[0,1] neg_hi:[0,1]
    v_exp_f32 v144, v144
    v_exp_f32 v145, v145
    v_exp_f32 v146, v146
    v_exp_f32 v147, v147
    v_exp_f32 v148, v148
    v_exp_f32 v149, v149
    v_exp_f32 v150, v150
    v_exp_f32 v151, v151
    v_pk_mul_f32 v[84:85], v[84:85], v[80:81]
    v_pk_mul_f32 v[86:87], v[86:87], v[82:83]
    v_pk_mul_f32 v[92:93], v[92:93], v[88:89]
    v_pk_mul_f32 v[94:95], v[94:95], v[90:91]
    v_pk_add_f32 v[144:145], v[144:145], 1.0 op_sel_hi:[1,0]
    v_pk_add_f32 v[146:147], v[146:147], 1.0 op_sel_hi:[1,0]
    v_pk_add_f32 v[148:149], v[148:149], 1.0 op_sel_hi:[1,0]
    v_pk_add_f32 v[150:151], v[150:151], 1.0 op_sel_hi:[1,0]
    v_rcp_f32 v144, v144
    v_rcp_f32 v145, v145
    v_rcp_f32 v146, v146
    v_rcp_f32 v147, v147
    v_rcp_f32 v148, v148
    v_rcp_f32 v149, v149
    v_rcp_f32 v150, v150
    v_rcp_f32 v151, v151
    v_pk_mul_f32 v[84:85], v[84:85], v[144:145]
    v_pk_mul_f32 v[86:87], v[86:87], v[146:147]
    v_pk_mul_f32 v[92:93], v[92:93], v[148:149]
    v_pk_mul_f32 v[94:95], v[94:95], v[150:151]
    v_cvt_pk_bf16_f32 v80, v84, v85
    v_cvt_pk_bf16_f32 v81, v86, v87
    v_cvt_pk_bf16_f32 v82, v92, v93
    v_cvt_pk_bf16_f32 v83, v94, v95
    s_add_u32 s75, s76, 458752
    buffer_store_dwordx4 v[80:83], v6, s[64:67], s75 offen offset:0 sc1
    v_pk_fma_f32 v[144:145], v[96:97], v[96:97], v[248:249] op_sel_hi:[1,1,0]
    v_pk_fma_f32 v[146:147], v[98:99], v[98:99], v[248:249] op_sel_hi:[1,1,0]
    v_pk_fma_f32 v[148:149], v[104:105], v[104:105], v[248:249] op_sel_hi:[1,1,0]
    v_pk_fma_f32 v[150:151], v[106:107], v[106:107], v[248:249] op_sel_hi:[1,1,0]
    v_pk_mul_f32 v[144:145], v[144:145], v[96:97] neg_lo:[0,1] neg_hi:[0,1]
    v_pk_mul_f32 v[146:147], v[146:147], v[98:99] neg_lo:[0,1] neg_hi:[0,1]
    v_pk_mul_f32 v[148:149], v[148:149], v[104:105] neg_lo:[0,1] neg_hi:[0,1]
    v_pk_mul_f32 v[150:151], v[150:151], v[106:107] neg_lo:[0,1] neg_hi:[0,1]
    v_exp_f32 v144, v144
    v_exp_f32 v145, v145
    v_exp_f32 v146, v146
    v_exp_f32 v147, v147
    v_exp_f32 v148, v148
    v_exp_f32 v149, v149
    v_exp_f32 v150, v150
    v_exp_f32 v151, v151
    v_pk_mul_f32 v[100:101], v[100:101], v[96:97]
    v_pk_mul_f32 v[102:103], v[102:103], v[98:99]
    v_pk_mul_f32 v[108:109], v[108:109], v[104:105]
    v_pk_mul_f32 v[110:111], v[110:111], v[106:107]
    v_pk_add_f32 v[144:145], v[144:145], 1.0 op_sel_hi:[1,0]
    v_pk_add_f32 v[146:147], v[146:147], 1.0 op_sel_hi:[1,0]
    v_pk_add_f32 v[148:149], v[148:149], 1.0 op_sel_hi:[1,0]
    v_pk_add_f32 v[150:151], v[150:151], 1.0 op_sel_hi:[1,0]
    v_rcp_f32 v144, v144
    v_rcp_f32 v145, v145
    v_rcp_f32 v146, v146
    v_rcp_f32 v147, v147
    v_rcp_f32 v148, v148
    v_rcp_f32 v149, v149
    v_rcp_f32 v150, v150
    v_rcp_f32 v151, v151
    v_pk_mul_f32 v[100:101], v[100:101], v[144:145]
    v_pk_mul_f32 v[102:103], v[102:103], v[146:147]
    v_pk_mul_f32 v[108:109], v[108:109], v[148:149]
    v_pk_mul_f32 v[110:111], v[110:111], v[150:151]
    v_cvt_pk_bf16_f32 v96, v100, v101
    v_cvt_pk_bf16_f32 v97, v102, v103
    v_cvt_pk_bf16_f32 v98, v108, v109
    v_cvt_pk_bf16_f32 v99, v110, v111
    s_waitcnt vmcnt(1)
    s_mov_b64 exec, 2
    s_cmp_eq_u32 s40, 0
    s_cbranch_scc1 slow_63
    buffer_store_dword v251, v250, s[64:67], s10 offen
    s_branch join_64
slow_63:
    buffer_store_dword v251, v250, s[64:67], s10 offen sc1
join_64:
    s_mov_b64 exec, -1
    s_add_u32 s75, s76, 458752
    buffer_store_dwordx4 v[96:99], v6, s[64:67], s75 offen offset:1024 sc1
    v_pk_fma_f32 v[144:145], v[112:113], v[112:113], v[248:249] op_sel_hi:[1,1,0]
    v_pk_fma_f32 v[146:147], v[114:115], v[114:115], v[248:249] op_sel_hi:[1,1,0]
    v_pk_fma_f32 v[148:149], v[120:121], v[120:121], v[248:249] op_sel_hi:[1,1,0]
    v_pk_fma_f32 v[150:151], v[122:123], v[122:123], v[248:249] op_sel_hi:[1,1,0]
    v_pk_mul_f32 v[144:145], v[144:145], v[112:113] neg_lo:[0,1] neg_hi:[0,1]
    v_pk_mul_f32 v[146:147], v[146:147], v[114:115] neg_lo:[0,1] neg_hi:[0,1]
    v_pk_mul_f32 v[148:149], v[148:149], v[120:121] neg_lo:[0,1] neg_hi:[0,1]
    v_pk_mul_f32 v[150:151], v[150:151], v[122:123] neg_lo:[0,1] neg_hi:[0,1]
    v_exp_f32 v144, v144
    v_exp_f32 v145, v145
    v_exp_f32 v146, v146
    v_exp_f32 v147, v147
    v_exp_f32 v148, v148
    v_exp_f32 v149, v149
    v_exp_f32 v150, v150
    v_exp_f32 v151, v151
    v_pk_mul_f32 v[116:117], v[116:117], v[112:113]
    v_pk_mul_f32 v[118:119], v[118:119], v[114:115]
    v_pk_mul_f32 v[124:125], v[124:125], v[120:121]
    v_pk_mul_f32 v[126:127], v[126:127], v[122:123]
    v_pk_add_f32 v[144:145], v[144:145], 1.0 op_sel_hi:[1,0]
    v_pk_add_f32 v[146:147], v[146:147], 1.0 op_sel_hi:[1,0]
    v_pk_add_f32 v[148:149], v[148:149], 1.0 op_sel_hi:[1,0]
    v_pk_add_f32 v[150:151], v[150:151], 1.0 op_sel_hi:[1,0]
    v_rcp_f32 v144, v144
    v_rcp_f32 v145, v145
    v_rcp_f32 v146, v146
    v_rcp_f32 v147, v147
    v_rcp_f32 v148, v148
    v_rcp_f32 v149, v149
    v_rcp_f32 v150, v150
    v_rcp_f32 v151, v151
    v_pk_mul_f32 v[116:117], v[116:117], v[144:145]
    v_pk_mul_f32 v[118:119], v[118:119], v[146:147]
    v_pk_mul_f32 v[124:125], v[124:125], v[148:149]
    v_pk_mul_f32 v[126:127], v[126:127], v[150:151]
    v_cvt_pk_bf16_f32 v112, v116, v117
    v_cvt_pk_bf16_f32 v113, v118, v119
    v_cvt_pk_bf16_f32 v114, v124, v125
    v_cvt_pk_bf16_f32 v115, v126, v127
    s_add_u32 s75, s76, 516096
    buffer_store_dwordx4 v[112:115], v6, s[64:67], s75 offen offset:0 sc1
    v_pk_fma_f32 v[144:145], v[128:129], v[128:129], v[248:249] op_sel_hi:[1,1,0]
    v_pk_fma_f32 v[146:147], v[130:131], v[130:131], v[248:249] op_sel_hi:[1,1,0]
    v_pk_fma_f32 v[148:149], v[136:137], v[136:137], v[248:249] op_sel_hi:[1,1,0]
    v_pk_fma_f32 v[150:151], v[138:139], v[138:139], v[248:249] op_sel_hi:[1,1,0]
    v_pk_mul_f32 v[144:145], v[144:145], v[128:129] neg_lo:[0,1] neg_hi:[0,1]
    v_pk_mul_f32 v[146:147], v[146:147], v[130:131] neg_lo:[0,1] neg_hi:[0,1]
    v_pk_mul_f32 v[148:149], v[148:149], v[136:137] neg_lo:[0,1] neg_hi:[0,1]
    v_pk_mul_f32 v[150:151], v[150:151], v[138:139] neg_lo:[0,1] neg_hi:[0,1]
    v_exp_f32 v144, v144
    v_exp_f32 v145, v145
    v_exp_f32 v146, v146
    v_exp_f32 v147, v147
    v_exp_f32 v148, v148
    v_exp_f32 v149, v149
    v_exp_f32 v150, v150
    v_exp_f32 v151, v151
    v_pk_mul_f32 v[132:133], v[132:133], v[128:129]
    v_pk_mul_f32 v[134:135], v[134:135], v[130:131]
    v_pk_mul_f32 v[140:141], v[140:141], v[136:137]
    v_pk_mul_f32 v[142:143], v[142:143], v[138:139]
    v_pk_add_f32 v[144:145], v[144:145], 1.0 op_sel_hi:[1,0]
    v_pk_add_f32 v[146:147], v[146:147], 1.0 op_sel_hi:[1,0]
    v_pk_add_f32 v[148:149], v[148:149], 1.0 op_sel_hi:[1,0]
    v_pk_add_f32 v[150:151], v[150:151], 1.0 op_sel_hi:[1,0]
    v_rcp_f32 v144, v144
    v_rcp_f32 v145, v145
    v_rcp_f32 v146, v146
    v_rcp_f32 v147, v147
    v_rcp_f32 v148, v148
    v_rcp_f32 v149, v149
    v_rcp_f32 v150, v150
    v_rcp_f32 v151, v151
    v_pk_mul_f32 v[132:133], v[132:133], v[144:145]
    v_pk_mul_f32 v[134:135], v[134:135], v[146:147]
    v_pk_mul_f32 v[140:141], v[140:141], v[148:149]
    v_pk_mul_f32 v[142:143], v[142:143], v[150:151]
    v_cvt_pk_bf16_f32 v128, v132, v133
    v_cvt_pk_bf16_f32 v129, v134, v135
    v_cvt_pk_bf16_f32 v130, v140, v141
    v_cvt_pk_bf16_f32 v131, v142, v143
    s_waitcnt vmcnt(1)
    s_mov_b64 exec, 4
    s_cmp_eq_u32 s40, 0
    s_cbranch_scc1 slow_65
    buffer_store_dword v251, v250, s[64:67], s10 offen
    s_branch join_66
slow_65:
    buffer_store_dword v251, v250, s[64:67], s10 offen sc1
join_66:
    s_mov_b64 exec, -1
    s_add_u32 s75, s76, 516096
    buffer_store_dwordx4 v[128:131], v6, s[64:67], s75 offen offset:1024 sc1
    s_waitcnt vmcnt(0)
    s_mov_b64 exec, 8
    s_cmp_eq_u32 s40, 0
    s_cbranch_scc1 slow_67
    buffer_store_dword v251, v250, s[64:67], s10 offen
    s_branch join_68
slow_67:
    buffer_store_dword v251, v250, s[64:67], s10 offen sc1
join_68:
    s_mov_b64 exec, -1
L_fin:
    s_mov_b32 s75, 0
    buffer_load_dwordx2 v[16:17], v12, s[44:47], s75 offen sc1
    s_mov_b32 s75, 16384
    buffer_load_dwordx2 v[20:21], v12, s[44:47], s75 offen sc1
    s_mov_b32 s75, 131072
    buffer_load_dwordx2 v[22:23], v12, s[44:47], s75 offen sc1
    s_mov_b32 s75, 147456
    buffer_load_dwordx2 v[24:25], v12, s[44:47], s75 offen sc1
    s_waitcnt vmcnt(3)
    v_lshlrev_b32 v48, 16, v16
    v_and_b32 v49, 0xffff0000, v16
    v_lshlrev_b32 v50, 16, v17
    v_and_b32 v51, 0xffff0000, v17
    s_mov_b32 s74, 0
lw_69:
    ds_read_b32 v15, v11 offset:0
    s_add_u32 s74, s74, 1
    s_waitcnt lgkmcnt(0)
    v_cmp_ne_u32 vcc, s38, v15
    s_cbranch_vccz lok_70
    s_cmp_lt_u32 s74, 2097152
    s_cbranch_scc1 lw_69
lok_70:
    ds_read_b128 v[52:55], v10 offset:0
    ds_read_b128 v[36:39], v10 offset:4096
    ds_read_b128 v[40:43], v10 offset:8192
    ds_read_b128 v[44:47], v10 offset:12288
    s_waitcnt lgkmcnt(2)
    v_add_f32 v52, v52, v36
    v_add_f32 v53, v53, v37
    v_add_f32 v54, v54, v38
    v_add_f32 v55, v55, v39
    s_waitcnt lgkmcnt(1)
    v_add_f32 v52, v52, v40
    v_add_f32 v53, v53, v41
    v_add_f32 v54, v54, v42
    v_add_f32 v55, v55, v43
    s_waitcnt lgkmcnt(0)
    v_add_f32 v52, v52, v44
    v_add_f32 v53, v53, v45
    v_add_f32 v54, v54, v46
    v_add_f32 v55, v55, v47
    v_fmac_f32 v48, v52, v2
    v_fmac_f32 v49, v53, v3
    v_fmac_f32 v50, v54, v4
    v_fmac_f32 v51, v55, v5
    v_cvt_pk_bf16_f32 v16, v48, v49
    v_cvt_pk_bf16_f32 v17, v50, v51
    s_mov_b32 s75, 0
    s_cmp_eq_u32 s40, 0
    s_cbranch_scc1 slow_71
    buffer_store_dwordx2 v[16:17], v12, s[44:47], s75 offen
    s_branch join_72
slow_71:
    buffer_store_dwordx2 v[16:17], v12, s[44:47], s75 offen sc1
join_72:
    s_mov_b32 s74, 0
lw_73:
    ds_read_b32 v15, v11 offset:32
    s_add_u32 s74, s74, 1
    s_waitcnt lgkmcnt(0)
    v_cmp_ne_u32 vcc, s38, v15
    s_cbranch_vccz lok_74
    s_cmp_lt_u32 s74, 2097152
    s_cbranch_scc1 lw_73
lok_74:
    ds_read_b128 v[56:59], v10 offset:16384
    ds_read_b128 v[36:39], v10 offset:20480
    ds_read_b128 v[40:43], v10 offset:24576
    ds_read_b128 v[44:47], v10 offset:28672
    s_waitcnt lgkmcnt(2)
    v_add_f32 v56, v56, v36
    v_add_f32 v57, v57, v37
    v_add_f32 v58, v58, v38
    v_add_f32 v59, v59, v39
    s_waitcnt lgkmcnt(1)
    v_add_f32 v56, v56, v40
    v_add_f32 v57, v57, v41
    v_add_f32 v58, v58, v42
    v_add_f32 v59, v59, v43
    s_waitcnt lgkmcnt(0)
    v_add_f32 v56, v56, v44
    v_add_f32 v57, v57, v45
    v_add_f32 v58, v58, v46
    v_add_f32 v59, v59, v47
    s_waitcnt vmcnt(3)
    v_lshlrev_b32 v48, 16, v20
    v_and_b32 v49, 0xffff0000, v20
    v_lshlrev_b32 v50, 16, v21
    v_and_b32 v51, 0xffff0000, v21
    s_mov_b32 s74, 0
lw_75:
    ds_read_b32 v15, v11 offset:64
    s_add_u32 s74, s74, 1
    s_waitcnt lgkmcnt(0)
    v_cmp_ne_u32 vcc, s38, v15
    s_cbranch_vccz lok_76
    s_cmp_lt_u32 s74, 2097152
    s_cbranch_scc1 lw_75
lok_76:
    ds_read_b128 v[60:63], v10 offset:32768
    ds_read_b128 v[36:39], v10 offset:36864
    ds_read_b128 v[40:43], v10 offset:40960
    ds_read_b128 v[44:47], v10 offset:45056
    s_waitcnt lgkmcnt(2)
    v_add_f32 v60, v60, v36
    v_add_f32 v61, v61, v37
    v_add_f32 v62, v62, v38
    v_add_f32 v63, v63, v39
    s_waitcnt lgkmcnt(1)
    v_add_f32 v60, v60, v40
    v_add_f32 v61, v61, v41
    v_add_f32 v62, v62, v42
    v_add_f32 v63, v63, v43
    s_waitcnt lgkmcnt(0)
    v_add_f32 v60, v60, v44
    v_add_f32 v61, v61, v45
    v_add_f32 v62, v62, v46
    v_add_f32 v63, v63, v47
    v_fmac_f32 v48, v60, v2
    v_fmac_f32 v49, v61, v3
    v_fmac_f32 v50, v62, v4
    v_fmac_f32 v51, v63, v5
    v_cvt_pk_bf16_f32 v20, v48, v49
    v_cvt_pk_bf16_f32 v21, v50, v51
    s_mov_b32 s75, 16384
    s_cmp_eq_u32 s40, 0
    s_cbranch_scc1 slow_77
    buffer_store_dwordx2 v[20:21], v12, s[44:47], s75 offen
    s_branch join_78
slow_77:
    buffer_store_dwordx2 v[20:21], v12, s[44:47], s75 offen sc1
join_78:
    s_waitcnt vmcnt(3)
    v_lshlrev_b32 v48, 16, v22
    v_and_b32 v49, 0xffff0000, v22
    v_lshlrev_b32 v50, 16, v23
    v_and_b32 v51, 0xffff0000, v23
    v_add_u32 v10, 65536, v10
    s_mov_b32 s74, 0
lw_79:
    ds_read_b32 v15, v11 offset:96
    s_add_u32 s74, s74, 1
    s_waitcnt lgkmcnt(0)
    v_cmp_ne_u32 vcc, s38, v15
    s_cbranch_vccz lok_80
    s_cmp_lt_u32 s74, 2097152
    s_cbranch_scc1 lw_79
lok_80:
    ds_read_b128 v[64:67], v10 offset:0
    ds_read_b128 v[36:39], v10 offset:4096
    ds_read_b128 v[40:43], v10 offset:8192
    ds_read_b128 v[44:47], v10 offset:12288
    s_waitcnt lgkmcnt(2)
    v_add_f32 v64, v64, v36
    v_add_f32 v65, v65, v37
    v_add_f32 v66, v66, v38
    v_add_f32 v67, v67, v39
    s_waitcnt lgkmcnt(1)
    v_add_f32 v64, v64, v40
    v_add_f32 v65, v65, v41
    v_add_f32 v66, v66, v42
    v_add_f32 v67, v67, v43
    s_waitcnt lgkmcnt(0)
    v_add_f32 v64, v64, v44
    v_add_f32 v65, v65, v45
    v_add_f32 v66, v66, v46
    v_add_f32 v67, v67, v47
    v_fmac_f32 v48, v64, v2
    v_fmac_f32 v49, v65, v3
    v_fmac_f32 v50, v66, v4
    v_fmac_f32 v51, v67, v5
    v_cvt_pk_bf16_f32 v22, v48, v49
    v_cvt_pk_bf16_f32 v23, v50, v51
    s_mov_b32 s75, 131072
    s_cmp_eq_u32 s40, 0
    s_cbranch_scc1 slow_81
    buffer_store_dwordx2 v[22:23], v12, s[44:47], s75 offen
    s_branch join_82
slow_81:
    buffer_store_dwordx2 v[22:23], v12, s[44:47], s75 offen sc1
join_82:
    s_waitcnt vmcnt(3)
    v_lshlrev_b32 v48, 16, v24
    v_and_b32 v49, 0xffff0000, v24
    v_lshlrev_b32 v50, 16, v25
    v_and_b32 v51, 0xffff0000, v25
    s_mov_b32 s74, 0
lw_83:
    ds_read_b32 v15, v11 offset:128
    s_add_u32 s74, s74, 1
    s_waitcnt lgkmcnt(0)
    v_cmp_ne_u32 vcc, s38, v15
    s_cbranch_vccz lok_84
    s_cmp_lt_u32 s74, 2097152
    s_cbranch_scc1 lw_83
lok_84:
    ds_read_b128 v[68:71], v10 offset:16384
    ds_read_b128 v[36:39], v10 offset:20480
    ds_read_b128 v[40:43], v10 offset:24576
    ds_read_b128 v[44:47], v10 offset:28672
    s_waitcnt lgkmcnt(2)
    v_add_f32 v68, v68, v36
    v_add_f32 v69, v69, v37
    v_add_f32 v70, v70, v38
    v_add_f32 v71, v71, v39
    s_waitcnt lgkmcnt(1)
    v_add_f32 v68, v68, v40
    v_add_f32 v69, v69, v41
    v_add_f32 v70, v70, v42
    v_add_f32 v71, v71, v43
    s_waitcnt lgkmcnt(0)
    v_add_f32 v68, v68, v44
    v_add_f32 v69, v69, v45
    v_add_f32 v70, v70, v46
    v_add_f32 v71, v71, v47
    v_fmac_f32 v48, v68, v2
    v_fmac_f32 v49, v69, v3
    v_fmac_f32 v50, v70, v4
    v_fmac_f32 v51, v71, v5
    v_cvt_pk_bf16_f32 v24, v48, v49
    v_cvt_pk_bf16_f32 v25, v50, v51
    s_mov_b32 s75, 147456
    s_cmp_eq_u32 s40, 0
    s_cbranch_scc1 slow_85
    buffer_store_dwordx2 v[24:25], v12, s[44:47], s75 offen
    s_branch join_86
slow_85:
    buffer_store_dwordx2 v[24:25], v12, s[44:47], s75 offen sc1
join_86:
    s_lshl_b32 s72, s34, 3
    s_add_u32 s72, s72, s36
    s_lshl_b32 s72, s72, 5
    s_add_u32 s72, s72, s35
    s_lshl_b32 s72, s72, 2
    s_add_u32 s72, s72, 32768
    v_mov_b32 v8, 0
    v_mov_b32 v9, s38
    s_waitcnt vmcnt(0)
    s_mov_b64 exec, 1
    s_cmp_eq_u32 s40, 0
    s_cbranch_scc1 slow_87
    buffer_store_dword v9, v8, s[64:67], s72 offen
    s_branch join_88
slow_87:
    buffer_store_dword v9, v8, s[64:67], s72 offen sc1
join_88:
    s_mov_b64 exec, -1
    s_mov_b32 s74, 0
lw_89:
    ds_read_b32 v15, v11 offset:160
    s_add_u32 s74, s74, 1
    s_waitcnt lgkmcnt(0)
    v_cmp_ne_u32 vcc, s38, v15
    s_cbranch_vccz lok_90
    s_cmp_lt_u32 s74, 2097152
    s_cbranch_scc1 lw_89
lok_90:
    ds_read_b128 v[72:75], v10 offset:32768
    ds_read_b128 v[36:39], v10 offset:36864
    ds_read_b128 v[40:43], v10 offset:40960
    ds_read_b128 v[44:47], v10 offset:45056
    s_waitcnt lgkmcnt(2)
    v_add_f32 v72, v72, v36
    v_add_f32 v73, v73, v37
    v_add_f32 v74, v74, v38
    v_add_f32 v75, v75, v39
    s_waitcnt lgkmcnt(1)
    v_add_f32 v72, v72, v40
    v_add_f32 v73, v73, v41
    v_add_f32 v74, v74, v42
    v_add_f32 v75, v75, v43
    s_waitcnt lgkmcnt(0)
    v_add_f32 v72, v72, v44
    v_add_f32 v73, v73, v45
    v_add_f32 v74, v74, v46
    v_add_f32 v75, v75, v47
    s_lshl_b32 s72, s34, 3
    s_add_u32 s72, s72, s36
    s_lshl_b32 s72, s72, 7
    s_add_u32 s72, s72, 32768
    s_mov_b32 s74, 0
poll_91:
    buffer_load_dword v9, v14, s[64:67], s72 offen sc1
    s_add_u32 s74, s74, 1
    s_waitcnt vmcnt(0)
    v_cmp_ne_u32 vcc, s38, v9
    s_cbranch_vccz seen_92
    s_cmp_lt_u32 s74, 131072
    s_cbranch_scc1 poll_91
seen_92:
    s_mov_b32 s75, 0
    buffer_load_dwordx2 v[18:19], v13, s[44:47], s75 offen sc1
    buffer_load_dwordx2 v[26:27], v13, s[44:47], s48 offen sc1
    buffer_load_dwordx2 v[28:29], v13, s[44:47], s49 offen sc1
    buffer_load_dwordx2 v[30:31], v13, s[44:47], s50 offen sc1
    s_mov_b32 s74, 0
lw_93:
    ds_read_b32 v15, v11 offset:192
    s_add_u32 s74, s74, 1
    s_waitcnt lgkmcnt(0)
    v_cmp_ne_u32 vcc, s38, v15
    s_cbranch_vccz lok_94
    s_cmp_lt_u32 s74, 2097152
    s_cbranch_scc1 lw_93
lok_94:
    ds_read_b128 v[76:79], v10 offset:49152
    ds_read_b128 v[36:39], v10 offset:53248
    ds_read_b128 v[40:43], v10 offset:57344
    ds_read_b128 v[44:47], v10 offset:61440
    s_waitcnt lgkmcnt(2)
    v_add_f32 v76, v76, v36
    v_add_f32 v77, v77, v37
    v_add_f32 v78, v78, v38
    v_add_f32 v79, v79, v39
    s_waitcnt lgkmcnt(1)
    v_add_f32 v76, v76, v40
    v_add_f32 v77, v77, v41
    v_add_f32 v78, v78, v42
    v_add_f32 v79, v79, v43
    s_waitcnt lgkmcnt(0)
    v_add_f32 v76, v76, v44
    v_add_f32 v77, v77, v45
    v_add_f32 v78, v78, v46
    v_add_f32 v79, v79, v47
    s_waitcnt vmcnt(3)
    v_lshlrev_b32 v48, 16, v18
    v_and_b32 v49, 0xffff0000, v18
    v_lshlrev_b32 v50, 16, v19
    v_and_b32 v51, 0xffff0000, v19
    v_fmac_f32 v48, v56, v2
    v_fmac_f32 v49, v57, v3
    v_fmac_f32 v50, v58, v4
    v_fmac_f32 v51, v59, v5
    v_cvt_pk_bf16_f32 v18, v48, v49
    v_cvt_pk_bf16_f32 v19, v50, v51
    s_mov_b32 s75, 0
    buffer_store_dwordx2 v[18:19], v13, s[44:47], s75 offen
    s_waitcnt vmcnt(3)
    v_lshlrev_b32 v48, 16, v26
    v_and_b32 v49, 0xffff0000, v26
    v_lshlrev_b32 v50, 16, v27
    v_and_b32 v51, 0xffff0000, v27
    v_fmac_f32 v48, v72, v2
    v_fmac_f32 v49, v73, v3
    v_fmac_f32 v50, v74, v4
    v_fmac_f32 v51, v75, v5
    v_cvt_pk_bf16_f32 v26, v48, v49
    v_cvt_pk_bf16_f32 v27, v50, v51
    buffer_store_dwordx2 v[26:27], v13, s[44:47], s48 offen
    s_waitcnt vmcnt(3)
    v_lshlrev_b32 v48, 16, v28
    v_and_b32 v49, 0xffff0000, v28
    v_lshlrev_b32 v50, 16, v29
    v_and_b32 v51, 0xffff0000, v29
    v_fmac_f32 v48, v76, v2
    v_fmac_f32 v49, v77, v3
    v_fmac_f32 v50, v78, v4
    v_fmac_f32 v51, v79, v5
    v_cvt_pk_bf16_f32 v28, v48, v49
    v_cvt_pk_bf16_f32 v29, v50, v51
    buffer_store_dwordx2 v[28:29], v13, s[44:47], s49 offen
    s_waitcnt vmcnt(3)
    v_lshlrev_b32 v48, 16, v30
    v_and_b32 v49, 0xffff0000, v30
    v_lshlrev_b32 v50, 16, v31
    v_and_b32 v51, 0xffff0000, v31
    v_add_u32 v10, 65536, v10
    s_mov_b32 s74, 0
lw_95:
    ds_read_b32 v15, v11 offset:224
    s_add_u32 s74, s74, 1
    s_waitcnt lgkmcnt(0)
    v_cmp_ne_u32 vcc, s38, v15
    s_cbranch_vccz lok_96
    s_cmp_lt_u32 s74, 2097152
    s_cbranch_scc1 lw_95
lok_96:
    ds_read_b128 v[80:83], v10 offset:0
    ds_read_b128 v[36:39], v10 offset:4096
    ds_read_b128 v[40:43], v10 offset:8192
    ds_read_b128 v[44:47], v10 offset:12288
    s_waitcnt lgkmcnt(2)
    v_add_f32 v80, v80, v36
    v_add_f32 v81, v81, v37
    v_add_f32 v82, v82, v38
    v_add_f32 v83, v83, v39
    s_waitcnt lgkmcnt(1)
    v_add_f32 v80, v80, v40
    v_add_f32 v81, v81, v41
    v_add_f32 v82, v82, v42
    v_add_f32 v83, v83, v43
    s_waitcnt lgkmcnt(0)
    v_add_f32 v80, v80, v44
    v_add_f32 v81, v81, v45
    v_add_f32 v82, v82, v46
    v_add_f32 v83, v83, v47
    v_fmac_f32 v48, v80, v2
    v_fmac_f32 v49, v81, v3
    v_fmac_f32 v50, v82, v4
    v_fmac_f32 v51, v83, v5
    v_cvt_pk_bf16_f32 v30, v48, v49
    v_cvt_pk_bf16_f32 v31, v50, v51
    buffer_store_dwordx2 v[30:31], v13, s[44:47], s50 offen
    s_branch L_done
loader_53:
    s_and_b32 s73, s36, 3
    s_add_u32 m0, s68, 0
    s_add_u32 s77, s69, 0
    buffer_load_dwordx4 v140, s[64:67], s77 offen sc1 lds
    s_add_u32 m0, s68, 1024
    s_add_u32 s77, s69, 8192
    buffer_load_dwordx4 v141, s[64:67], s77 offen sc1 lds
    s_add_u32 m0, s68, 2048
    s_add_u32 s77, s69, 16384
    buffer_load_dwordx4 v140, s[64:67], s77 offen sc1 lds
    s_add_u32 m0, s68, 3072
    s_add_u32 s77, s69, 24576
    buffer_load_dwordx4 v141, s[64:67], s77 offen sc1 lds
    s_mov_b32 s74, 0
    s_branch h0c_98
h0_97:
    s_add_u32 m0, s68, 0
    s_add_u32 s77, s69, 0
    buffer_load_dwordx4 v140, s[64:67], s77 offen sc1 lds
    s_add_u32 m0, s68, 1024
    s_add_u32 s77, s69, 8192
    buffer_load_dwordx4 v141, s[64:67], s77 offen sc1 lds
    s_add_u32 m0, s68, 2048
    s_add_u32 s77, s69, 16384
    buffer_load_dwordx4 v140, s[64:67], s77 offen sc1 lds
    s_add_u32 m0, s68, 3072
    s_add_u32 s77, s69, 24576
    buffer_load_dwordx4 v141, s[64:67], s77 offen sc1 lds
h0c_98:
    s_waitcnt vmcnt(0)
    ds_read2st64_b32 v[22:23], v20 offset0:0 offset1:4
    ds_read2st64_b32 v[24:25], v20 offset0:8 offset1:12
    s_add_u32 s74, s74, 1
    s_waitcnt lgkmcnt(0)
    v_max3_u32 v22, v22, v23, v24
    v_max_u32 v22, v22, v25
    v_cmp_eq_u32 vcc, -1, v22
    s_cbranch_vccz h0d_99
    s_cmp_lt_u32 s74, 131072
    s_cbranch_scc1 h0_97
h0d_99:
    s_lshl_b32 s72, s34, 3
    s_add_u32 s72, s72, s73
    s_lshl_b32 s72, s72, 7
    s_add_u32 s72, s72, 24576
    s_mov_b32 s74, 0
poll_100:
    buffer_load_dword v9, v135, s[64:67], s72 offen sc1
    s_add_u32 s74, s74, 1
    s_waitcnt vmcnt(0)
    v_cmp_ne_u32 vcc, s38, v9
    s_cbranch_vccz seen_101
    s_cmp_lt_u32 s74, 131072
    s_cbranch_scc1 poll_100
seen_101:
    s_add_u32 s75, s34, 1
    s_and_b32 s75, s75, 7
    s_lshl_b32 s75, s75, 7
    s_add_u32 s75, s75, s98
    s_add_u32 m0, s17, 131072
    s_add_u32 s77, s75, 0
    buffer_load_dwordx4 v140, s[64:67], s77 offen sc1 lds
    s_add_u32 m0, s17, 132096
    s_add_u32 s77, s75, 8192
    buffer_load_dwordx4 v141, s[64:67], s77 offen sc1 lds
    s_add_u32 m0, s17, 133120
    s_add_u32 s77, s75, 16384
    buffer_load_dwordx4 v140, s[64:67], s77 offen sc1 lds
    s_add_u32 m0, s17, 134144
    s_add_u32 s77, s75, 24576
    buffer_load_dwordx4 v141, s[64:67], s77 offen sc1 lds
    s_add_u32 m0, s17, 147456
    s_add_u32 s77, s75, 131072
    buffer_load_dwordx4 v140, s[64:67], s77 offen sc1 lds
    s_add_u32 m0, s17, 148480
    s_add_u32 s77, s75, 139264
    buffer_load_dwordx4 v141, s[64:67], s77 offen sc1 lds
    s_add_u32 m0, s17, 149504
    s_add_u32 s77, s75, 147456
    buffer_load_dwordx4 v140, s[64:67], s77 offen sc1 lds
    s_add_u32 m0, s17, 150528
    s_add_u32 s77, s75, 155648
    buffer_load_dwordx4 v141, s[64:67], s77 offen sc1 lds
    s_barrier
    s_add_u32 s75, s34, 2
    s_and_b32 s75, s75, 7
    s_lshl_b32 s75, s75, 7
    s_add_u32 s75, s75, s98
    s_add_u32 m0, s17, 98304
    s_add_u32 s77, s75, 0
    buffer_load_dwordx4 v140, s[64:67], s77 offen sc1 lds
    s_add_u32 m0, s17, 99328
    s_add_u32 s77, s75, 8192
    buffer_load_dwordx4 v141, s[64:67], s77 offen sc1 lds
    s_add_u32 m0, s17, 100352
    s_add_u32 s77, s75, 16384
    buffer_load_dwordx4 v140, s[64:67], s77 offen sc1 lds
    s_add_u32 m0, s17, 101376
    s_add_u32 s77, s75, 24576
    buffer_load_dwordx4 v141, s[64:67], s77 offen sc1 lds
    s_add_u32 m0, s17, 114688
    s_add_u32 s77, s75, 131072
    buffer_load_dwordx4 v140, s[64:67], s77 offen sc1 lds
    s_add_u32 m0, s17, 115712
    s_add_u32 s77, s75, 139264
    buffer_load_dwordx4 v141, s[64:67], s77 offen sc1 lds
    s_add_u32 m0, s17, 116736
    s_add_u32 s77, s75, 147456
    buffer_load_dwordx4 v140, s[64:67], s77 offen sc1 lds
    s_add_u32 m0, s17, 117760
    s_add_u32 s77, s75, 155648
    buffer_load_dwordx4 v141, s[64:67], s77 offen sc1 lds
    s_add_u32 s101, s34, 2
    s_and_b32 s101, s101, 7
    s_mul_i32 s101, s101, 229376
    s_add_u32 m0, s100, 32768
    s_nop 0
    buffer_load_dwordx4 v137, s[52:55], s101 offen lds
    s_add_u32 m0, s100, 28672
    s_nop 0
    buffer_load_dwordx4 v136, s[52:55], s101 offen lds
    s_add_u32 m0, s100, 40960
    s_nop 0
    buffer_load_dwordx4 v137, s[56:59], s101 offen lds
    s_add_u32 m0, s100, 36864
    s_nop 0
    buffer_load_dwordx4 v136, s[56:59], s101 offen lds
    s_waitcnt vmcnt(12)
    s_barrier
    s_add_u32 s75, s34, 3
    s_and_b32 s75, s75, 7
    s_lshl_b32 s75, s75, 7
    s_add_u32 s75, s75, s98
    s_add_u32 m0, s17, 65536
    s_add_u32 s77, s75, 0
    buffer_load_dwordx4 v140, s[64:67], s77 offen sc1 lds
    s_add_u32 m0, s17, 66560
    s_add_u32 s77, s75, 8192
    buffer_load_dwordx4 v141, s[64:67], s77 offen sc1 lds
    s_add_u32 m0, s17, 67584
    s_add_u32 s77, s75, 16384
    buffer_load_dwordx4 v140, s[64:67], s77 offen sc1 lds
    s_add_u32 m0, s17, 68608
    s_add_u32 s77, s75, 24576
    buffer_load_dwordx4 v141, s[64:67], s77 offen sc1 lds
    s_add_u32 m0, s17, 81920
    s_add_u32 s77, s75, 131072
    buffer_load_dwordx4 v140, s[64:67], s77 offen sc1 lds
    s_add_u32 m0, s17, 82944
    s_add_u32 s77, s75, 139264
    buffer_load_dwordx4 v141, s[64:67], s77 offen sc1 lds
    s_add_u32 m0, s17, 83968
    s_add_u32 s77, s75, 147456
    buffer_load_dwordx4 v140, s[64:67], s77 offen sc1 lds
    s_add_u32 m0, s17, 84992
    s_add_u32 s77, s75, 155648
    buffer_load_dwordx4 v141, s[64:67], s77 offen sc1 lds
    s_getpc_b64 s[78:79]
pc_102:
    s_sub_u32 s78, s78, pc_102-L_g1
    s_subb_u32 s79, s79, 0
    s_and_b32 s77, s36, 3
    s_mul_i32 s77, s77, 28
    s_add_u32 s77, s77, s35
    s_lshl_b32 s77, s77, 8
    v_and_b32 v133, 1, v1
    v_lshl_add_u32 v133, v133, 7, s77
    v_min_u32 v133, L_last-L_g1, v133
    global_load_dword v132, v133, s[78:79]
    s_add_u32 s101, s34, 3
    s_and_b32 s101, s101, 7
    s_mul_i32 s101, s101, 229376
    s_add_u32 m0, s100, 49152
    s_nop 0
    buffer_load_dwordx4 v137, s[52:55], s101 offen lds
    s_add_u32 m0, s100, 45056
    s_nop 0
    buffer_load_dwordx4 v136, s[52:55], s101 offen lds
    s_add_u32 m0, s100, 57344
    s_nop 0
    buffer_load_dwordx4 v137, s[56:59], s101 offen lds
    s_add_u32 m0, s100, 53248
    s_nop 0
    buffer_load_dwordx4 v136, s[56:59], s101 offen lds
    v_lshrrev_b32 v9, 2, v1
    v_bfe_u32 v8, v1, 3, 2
    v_lshlrev_b32 v9, 7, v9
    v_lshl_add_u32 v9, v8, 5, v9
    v_and_b32 v8, 3, v1
    v_lshl_add_u32 v9, v8, 3, v9
    v_add_u32 v16, s17, v9
    v_xor_b32 v17, 32, v16
    v_xor_b32 v18, 64, v16
    v_xor_b32 v19, 96, v16
    v_add_u32 v20, 65536, v16
    v_add_u32 v21, 65536, v17
    v_add_u32 v22, 65536, v18
    v_add_u32 v23, 65536, v19
    s_and_b32 s4, s36, 3
    s_and_b32 s5, s35, 3
    s_and_b32 s72, s35, 1
    s_lshl_b32 s72, s72, 2
    s_waitcnt vmcnt(13)
    s_barrier
    s_add_u32 s75, s34, 4
    s_and_b32 s75, s75, 7
    s_lshl_b32 s75, s75, 7
    s_add_u32 s75, s75, s98
    s_add_u32 m0, s17, 131072
    s_add_u32 s77, s75, 0
    buffer_load_dwordx4 v140, s[64:67], s77 offen sc1 lds
    s_add_u32 m0, s17, 132096
    s_add_u32 s77, s75, 8192
    buffer_load_dwordx4 v141, s[64:67], s77 offen sc1 lds
    s_add_u32 m0, s17, 133120
    s_add_u32 s77, s75, 16384
    buffer_load_dwordx4 v140, s[64:67], s77 offen sc1 lds
    s_add_u32 m0, s17, 134144
    s_add_u32 s77, s75, 24576
    buffer_load_dwordx4 v141, s[64:67], s77 offen sc1 lds
    s_add_u32 m0, s17, 147456
    s_add_u32 s77, s75, 131072
    buffer_load_dwordx4 v140, s[64:67], s77 offen sc1 lds
    s_add_u32 m0, s17, 148480
    s_add_u32 s77, s75, 139264
    buffer_load_dwordx4 v141, s[64:67], s77 offen sc1 lds
    s_add_u32 m0, s17, 149504
    s_add_u32 s77, s75, 147456
    buffer_load_dwordx4 v140, s[64:67], s77 offen sc1 lds
    s_add_u32 m0, s17, 150528
    s_add_u32 s77, s75, 155648
    buffer_load_dwordx4 v141, s[64:67], s77 offen sc1 lds
    s_add_u32 s101, s34, 4
    s_and_b32 s101, s101, 7
    s_mul_i32 s101, s101, 229376
    s_add_u32 m0, s100, 0
    s_nop 0
    buffer_load_dwordx4 v137, s[52:55], s101 offen lds
    s_add_u32 m0, s100, 4294963200
    s_nop 0
    buffer_load_dwordx4 v136, s[52:55], s101 offen lds
    s_add_u32 m0, s100, 8192
    s_nop 0
    buffer_load_dwordx4 v137, s[56:59], s101 offen lds
    s_add_u32 m0, s100, 4096
    s_nop 0
    buffer_load_dwordx4 v136, s[56:59], s101 offen lds
    s_add_u32 s72, s72, s4
    s_mul_i32 s10, s72, 7
    s_lshr_b32 s72, s10, 1
    v_and_b32 v8, 3, v1
    v_add_lshl_u32 v8, v8, s72, 2
    v_bfe_u32 v9, v1, 2, 1
    v_lshl_add_u32 v15, v9, 8, v8
    s_mul_i32 s73, s34, 917504
    s_lshl_b32 s10, s10, 10
    s_add_u32 s10, s10, s73
    s_add_u32 s10, s10, 11534336
    s_mul_i32 s72, s5, 114688
    s_add_u32 s6, s10, s72
    s_xor_b32 s72, s5, 1
    s_mul_i32 s72, s72, 114688
    s_add_u32 s7, s10, s72
    s_and_b32 s8, s35, 2
    s_lshl_b32 s8, s8, 1
    s_waitcnt vmcnt(12)
    s_barrier
    s_add_u32 s75, s34, 5
    s_and_b32 s75, s75, 7
    s_lshl_b32 s75, s75, 7
    s_add_u32 s75, s75, s98
    s_add_u32 m0, s17, 98304
    s_add_u32 s77, s75, 0
    buffer_load_dwordx4 v140, s[64:67], s77 offen sc1 lds
    s_add_u32 m0, s17, 99328
    s_add_u32 s77, s75, 8192
    buffer_load_dwordx4 v141, s[64:67], s77 offen sc1 lds
    s_add_u32 m0, s17, 100352
    s_add_u32 s77, s75, 16384
    buffer_load_dwordx4 v140, s[64:67], s77 offen sc1 lds
    s_add_u32 m0, s17, 101376
    s_add_u32 s77, s75, 24576
    buffer_load_dwordx4 v141, s[64:67], s77 offen sc1 lds
    s_add_u32 m0, s17, 114688
    s_add_u32 s77, s75, 131072
    buffer_load_dwordx4 v140, s[64:67], s77 offen sc1 lds
    s_add_u32 m0, s17, 115712
    s_add_u32 s77, s75, 139264
    buffer_load_dwordx4 v141, s[64:67], s77 offen sc1 lds
    s_add_u32 m0, s17, 116736
    s_add_u32 s77, s75, 147456
    buffer_load_dwordx4 v140, s[64:67], s77 offen sc1 lds
    s_add_u32 m0, s17, 117760
    s_add_u32 s77, s75, 155648
    buffer_load_dwordx4 v141, s[64:67], s77 offen sc1 lds
    s_add_u32 s101, s34, 5
    s_and_b32 s101, s101, 7
    s_mul_i32 s101, s101, 229376
    s_add_u32 m0, s100, 16384
    s_nop 0
    buffer_load_dwordx4 v137, s[52:55], s101 offen lds
    s_add_u32 m0, s100, 12288
    s_nop 0
    buffer_load_dwordx4 v136, s[52:55], s101 offen lds
    s_add_u32 m0, s100, 24576
    s_nop 0
    buffer_load_dwordx4 v137, s[56:59], s101 offen lds
    s_add_u32 m0, s100, 20480
    s_nop 0
    buffer_load_dwordx4 v136, s[56:59], s101 offen lds
    s_lshl_b32 s72, s34, 3
    s_add_u32 s72, s72, s8
    s_lshl_b32 s72, s72, 7
    s_add_u32 s10, s72, 40960
    s_add_u32 s9, s72, 49152
    v_lshlrev_b32 v6, 4, v1
    v_add_u32 v7, 4096, v6
    v_lshrrev_b32 v9, 4, v1
    v_add_u32 v10, v9, v1
    v_and_b32 v8, 48, v1
    s_lshl_b32 s72, s4, 12
    v_add_u32 v13, 12, v10
    v_and_b32 v13, 15, v13
    v_or_b32 v13, v13, v8
    v_lshl_add_u32 v13, v13, 4, s72
    v_add_u32 v12, 8, v10
    v_and_b32 v12, 15, v12
    s_waitcnt vmcnt(12)
    s_barrier
    s_add_u32 s75, s34, 6
    s_and_b32 s75, s75, 7
    s_lshl_b32 s75, s75, 7
    s_add_u32 s75, s75, s98
    s_add_u32 m0, s17, 65536
    s_add_u32 s77, s75, 0
    buffer_load_dwordx4 v140, s[64:67], s77 offen sc1 lds
    s_add_u32 m0, s17, 66560
    s_add_u32 s77, s75, 8192
    buffer_load_dwordx4 v141, s[64:67], s77 offen sc1 lds
    s_add_u32 m0, s17, 67584
    s_add_u32 s77, s75, 16384
    buffer_load_dwordx4 v140, s[64:67], s77 offen sc1 lds
    s_add_u32 m0, s17, 68608
    s_add_u32 s77, s75, 24576
    buffer_load_dwordx4 v141, s[64:67], s77 offen sc1 lds
    s_add_u32 m0, s17, 81920
    s_add_u32 s77, s75, 131072
    buffer_load_dwordx4 v140, s[64:67], s77 offen sc1 lds
    s_add_u32 m0, s17, 82944
    s_add_u32 s77, s75, 139264
    buffer_load_dwordx4 v141, s[64:67], s77 offen sc1 lds
    s_add_u32 m0, s17, 83968
    s_add_u32 s77, s75, 147456
    buffer_load_dwordx4 v140, s[64:67], s77 offen sc1 lds
    s_add_u32 m0, s17, 84992
    s_add_u32 s77, s75, 155648
    buffer_load_dwordx4 v141, s[64:67], s77 offen sc1 lds
    s_getpc_b64 s[78:79]
pc_103:
    s_sub_u32 s78, s78, pc_103-L_g1
    s_subb_u32 s79, s79, 0
    s_and_b32 s77, s36, 3
    s_mul_i32 s77, s77, 28
    s_add_u32 s77, s77, s35
    s_lshl_b32 s77, s77, 8
    v_and_b32 v133, 1, v1
    v_lshl_add_u32 v133, v133, 7, s77
    v_min_u32 v133, L_last-L_g1, v133
    global_load_dword v132, v133, s[78:79]
    s_add_u32 s101, s34, 6
    s_and_b32 s101, s101, 7
    s_mul_i32 s101, s101, 229376
    s_add_u32 m0, s100, 32768
    s_nop 0
    buffer_load_dwordx4 v137, s[52:55], s101 offen lds
    s_add_u32 m0, s100, 28672
    s_nop 0
    buffer_load_dwordx4 v136, s[52:55], s101 offen lds
    s_add_u32 m0, s100, 40960
    s_nop 0
    buffer_load_dwordx4 v137, s[56:59], s101 offen lds
    s_add_u32 m0, s100, 36864
    s_nop 0
    buffer_load_dwordx4 v136, s[56:59], s101 offen lds
    v_or_b32 v12, v12, v8
    v_lshl_add_u32 v12, v12, 4, s72
    v_add_u32 v11, 4, v10
    v_and_b32 v11, 15, v11
    v_or_b32 v11, v11, v8
    v_lshl_add_u32 v11, v11, 4, s72
    v_add_u32 v10, 0, v10
    v_and_b32 v10, 15, v10
    v_or_b32 v10, v10, v8
    v_lshl_add_u32 v10, v10, 4, s72
    s_lshl_b32 s72, s4, 2
    s_add_u32 s72, s72, 49152
    v_mov_b32 v14, s72
    v_mov_b32 v5, s38
    s_lshr_b32 s72, s35, 2
    s_sub_u32 s73, s72, 3
    s_min_u32 s72, s72, s73
    s_waitcnt vmcnt(13)
    s_barrier
    s_add_u32 s75, s34, 7
    s_and_b32 s75, s75, 7
    s_lshl_b32 s75, s75, 7
    s_add_u32 s75, s75, s98
    s_add_u32 m0, s17, 131072
    s_add_u32 s77, s75, 0
    buffer_load_dwordx4 v140, s[64:67], s77 offen sc1 lds
    s_add_u32 m0, s17, 132096
    s_add_u32 s77, s75, 8192
    buffer_load_dwordx4 v141, s[64:67], s77 offen sc1 lds
    s_add_u32 m0, s17, 133120
    s_add_u32 s77, s75, 16384
    buffer_load_dwordx4 v140, s[64:67], s77 offen sc1 lds
    s_add_u32 m0, s17, 134144
    s_add_u32 s77, s75, 24576
    buffer_load_dwordx4 v141, s[64:67], s77 offen sc1 lds
    s_add_u32 m0, s17, 147456
    s_add_u32 s77, s75, 131072
    buffer_load_dwordx4 v140, s[64:67], s77 offen sc1 lds
    s_add_u32 m0, s17, 148480
    s_add_u32 s77, s75, 139264
    buffer_load_dwordx4 v141, s[64:67], s77 offen sc1 lds
    s_add_u32 m0, s17, 149504
    s_add_u32 s77, s75, 147456
    buffer_load_dwordx4 v140, s[64:67], s77 offen sc1 lds
    s_add_u32 m0, s17, 150528
    s_add_u32 s77, s75, 155648
    buffer_load_dwordx4 v141, s[64:67], s77 offen sc1 lds
    v_mov_b32 v134, 0
    buffer_load_dword v134, v134, s[64:67], s97 offen sc1
    s_add_u32 s101, s34, 7
    s_and_b32 s101, s101, 7
    s_mul_i32 s101, s101, 229376
    s_add_u32 m0, s100, 49152
    s_nop 0
    buffer_load_dwordx4 v137, s[52:55], s101 offen lds
    s_add_u32 m0, s100, 45056
    s_nop 0
    buffer_load_dwordx4 v136, s[52:55], s101 offen lds
    s_add_u32 m0, s100, 57344
    s_nop 0
    buffer_load_dwordx4 v137, s[56:59], s101 offen lds
    s_add_u32 m0, s100, 53248
    s_nop 0
    buffer_load_dwordx4 v136, s[56:59], s101 offen lds
    s_sub_u32 s73, s72, 3
    s_min_u32 s72, s72, s73
    s_mov_b32 s48, 57344
    s_cmp_eq_u32 s72, 1
    s_cselect_b32 s48, 458752, s48
    s_cmp_eq_u32 s72, 2
    s_cselect_b32 s48, 516096, s48
    s_mov_b32 s49, 458752
    s_cmp_eq_u32 s72, 1
    s_cselect_b32 s49, 516096, s49
    s_cmp_eq_u32 s72, 2
    s_cselect_b32 s49, 57344, s49
    s_mov_b32 s50, 516096
    s_cmp_eq_u32 s72, 1
    s_cselect_b32 s50, 57344, s50
    s_cmp_eq_u32 s72, 2
    s_cselect_b32 s50, 458752, s50
    s_waitcnt vmcnt(13)
    s_barrier
    s_add_u32 m0, s17, 0
    s_add_u32 s77, s16, 0
    buffer_load_dwordx4 v142, s[60:63], s77 offen lds
    s_add_u32 m0, s17, 1024
    s_add_u32 s77, s16, 8192
    buffer_load_dwordx4 v142, s[60:63], s77 offen lds
    s_add_u32 m0, s17, 2048
    s_add_u32 s77, s16, 16384
    buffer_load_dwordx4 v142, s[60:63], s77 offen lds
    s_add_u32 m0, s17, 3072
    s_add_u32 s77, s16, 24576
    buffer_load_dwordx4 v142, s[60:63], s77 offen lds
    s_add_u32 m0, s17, 98304
    s_add_u32 s77, s16, 32768
    buffer_load_dwordx4 v142, s[60:63], s77 offen lds
    s_add_u32 m0, s17, 99328
    s_add_u32 s77, s16, 40960
    buffer_load_dwordx4 v142, s[60:63], s77 offen lds
    s_add_u32 m0, s17, 100352
    s_add_u32 s77, s16, 49152
    buffer_load_dwordx4 v142, s[60:63], s77 offen lds
    s_add_u32 m0, s17, 101376
    s_add_u32 s77, s16, 57344
    buffer_load_dwordx4 v142, s[60:63], s77 offen lds
    s_add_u32 m0, s17, 114688
    s_add_u32 s77, s16, 65536
    buffer_load_dwordx4 v142, s[60:63], s77 offen lds
    s_add_u32 m0, s17, 115712
    s_add_u32 s77, s16, 73728
    buffer_load_dwordx4 v142, s[60:63], s77 offen lds
    s_add_u32 m0, s17, 116736
    s_add_u32 s77, s16, 81920
    buffer_load_dwordx4 v142, s[60:63], s77 offen lds
    s_add_u32 m0, s17, 117760
    s_add_u32 s77, s16, 90112
    buffer_load_dwordx4 v142, s[60:63], s77 offen lds
    s_waitcnt vmcnt(12)
    s_barrier
    s_add_u32 m0, s17, 16384
    s_add_u32 s77, s16, 98304
    buffer_load_dwordx4 v142, s[60:63], s77 offen lds
    s_add_u32 m0, s17, 17408
    s_add_u32 s77, s16, 106496
    buffer_load_dwordx4 v142, s[60:63], s77 offen lds
    s_add_u32 m0, s17, 18432
    s_add_u32 s77, s16, 114688
    buffer_load_dwordx4 v142, s[60:63], s77 offen lds
    s_add_u32 m0, s17, 19456
    s_add_u32 s77, s16, 122880
    buffer_load_dwordx4 v142, s[60:63], s77 offen lds
    s_add_u32 m0, s17, 65536
    s_add_u32 s77, s16, 131072
    buffer_load_dwordx4 v142, s[60:63], s77 offen lds
    s_add_u32 m0, s17, 66560
    s_add_u32 s77, s16, 139264
    buffer_load_dwordx4 v142, s[60:63], s77 offen lds
    s_add_u32 m0, s17, 67584
    s_add_u32 s77, s16, 147456
    buffer_load_dwordx4 v142, s[60:63], s77 offen lds
    s_add_u32 m0, s17, 68608
    s_add_u32 s77, s16, 155648
    buffer_load_dwordx4 v142, s[60:63], s77 offen lds
    s_add_u32 m0, s17, 81920
    s_add_u32 s77, s16, 163840
    buffer_load_dwordx4 v142, s[60:63], s77 offen lds
    s_add_u32 m0, s17, 82944
    s_add_u32 s77, s16, 172032
    buffer_load_dwordx4 v142, s[60:63], s77 offen lds
    s_add_u32 m0, s17, 83968
    s_add_u32 s77, s16, 180224
    buffer_load_dwordx4 v142, s[60:63], s77 offen lds
    s_add_u32 m0, s17, 84992
    s_add_u32 s77, s16, 188416
    buffer_load_dwordx4 v142, s[60:63], s77 offen lds
    s_add_u32 m0, s17, 32768
    s_add_u32 s77, s16, 196608
    buffer_load_dwordx4 v142, s[60:63], s77 offen lds
    s_add_u32 m0, s17, 33792
    s_add_u32 s77, s16, 204800
    buffer_load_dwordx4 v142, s[60:63], s77 offen lds
    s_add_u32 m0, s17, 34816
    s_add_u32 s77, s16, 212992
    buffer_load_dwordx4 v142, s[60:63], s77 offen lds
    s_add_u32 m0, s17, 35840
    s_add_u32 s77, s16, 221184
    buffer_load_dwordx4 v142, s[60:63], s77 offen lds
    s_waitcnt vmcnt(24)
    ds_read_b64_tr_b16 v[144:145], v16 offset:0
    ds_read_b64_tr_b16 v[146:147], v16 offset:2048
    ds_read_b64_tr_b16 v[148:149], v17 offset:0
    ds_read_b64_tr_b16 v[150:151], v17 offset:2048
    ds_read_b64_tr_b16 v[152:153], v18 offset:0
    ds_read_b64_tr_b16 v[154:155], v18 offset:2048
    ds_read_b64_tr_b16 v[156:157], v19 offset:0
    ds_read_b64_tr_b16 v[158:159], v19 offset:2048
    s_waitcnt vmcnt(20)
    ds_read_b64_tr_b16 v[160:161], v20 offset:32768
    ds_read_b64_tr_b16 v[162:163], v20 offset:34816
    ds_read_b64_tr_b16 v[164:165], v21 offset:32768
    ds_read_b64_tr_b16 v[166:167], v21 offset:34816
    ds_read_b64_tr_b16 v[168:169], v22 offset:32768
    ds_read_b64_tr_b16 v[170:171], v22 offset:34816
    ds_read_b64_tr_b16 v[172:173], v23 offset:32768
    ds_read_b64_tr_b16 v[174:175], v23 offset:34816
    s_waitcnt vmcnt(16)
    ds_read_b64_tr_b16 v[176:177], v20 offset:49152
    ds_read_b64_tr_b16 v[178:179], v20 offset:51200
    ds_read_b64_tr_b16 v[180:181], v21 offset:49152
    ds_read_b64_tr_b16 v[182:183], v21 offset:51200
    ds_read_b64_tr_b16 v[184:185], v22 offset:49152
    ds_read_b64_tr_b16 v[186:187], v22 offset:51200
    ds_read_b64_tr_b16 v[188:189], v23 offset:49152
    ds_read_b64_tr_b16 v[190:191], v23 offset:51200
    s_waitcnt vmcnt(12)
    ds_read_b64_tr_b16 v[192:193], v16 offset:16384
    ds_read_b64_tr_b16 v[194:195], v16 offset:18432
    ds_read_b64_tr_b16 v[196:197], v17 offset:16384
    ds_read_b64_tr_b16 v[198:199], v17 offset:18432
    ds_read_b64_tr_b16 v[200:201], v18 offset:16384
    ds_read_b64_tr_b16 v[202:203], v18 offset:18432
    ds_read_b64_tr_b16 v[204:205], v19 offset:16384
    ds_read_b64_tr_b16 v[206:207], v19 offset:18432
    s_waitcnt vmcnt(8)
    ds_read_b64_tr_b16 v[208:209], v20 offset:0
    ds_read_b64_tr_b16 v[210:211], v20 offset:2048
    ds_read_b64_tr_b16 v[212:213], v21 offset:0
    ds_read_b64_tr_b16 v[214:215], v21 offset:2048
    ds_read_b64_tr_b16 v[216:217], v22 offset:0
    ds_read_b64_tr_b16 v[218:219], v22 offset:2048
    ds_read_b64_tr_b16 v[220:221], v23 offset:0
    ds_read_b64_tr_b16 v[222:223], v23 offset:2048
    s_waitcnt vmcnt(4)
    ds_read_b64_tr_b16 v[224:225], v20 offset:16384
    ds_read_b64_tr_b16 v[226:227], v20 offset:18432
    ds_read_b64_tr_b16 v[228:229], v21 offset:16384
    ds_read_b64_tr_b16 v[230:231], v21 offset:18432
    ds_read_b64_tr_b16 v[232:233], v22 offset:16384
    ds_read_b64_tr_b16 v[234:235], v22 offset:18432
    ds_read_b64_tr_b16 v[236:237], v23 offset:16384
    ds_read_b64_tr_b16 v[238:239], v23 offset:18432
    s_waitcnt vmcnt(0)
    ds_read_b64_tr_b16 v[240:241], v16 offset:32768
    ds_read_b64_tr_b16 v[242:243], v16 offset:34816
    ds_read_b64_tr_b16 v[244:245], v17 offset:32768
    ds_read_b64_tr_b16 v[246:247], v17 offset:34816
    ds_read_b64_tr_b16 v[248:249], v18 offset:32768
    ds_read_b64_tr_b16 v[250:251], v18 offset:34816
    ds_read_b64_tr_b16 v[252:253], v19 offset:32768
    ds_read_b64_tr_b16 v[254:255], v19 offset:34816
    s_barrier
L_mul:
    s_waitcnt lgkmcnt(0)
    s_lshl_b32 s72, s34, 3
    s_add_u32 s72, s72, s8
    s_lshl_b32 s72, s72, 7
    s_add_u32 s72, s72, 40960
    s_mov_b32 s74, 0
poll_104:
    buffer_load_dword v9, v15, s[64:67], s72 offen sc1
    s_add_u32 s74, s74, 1
    s_waitcnt vmcnt(0)
    v_cmp_ne_u32 vcc, s38, v9
    s_cbranch_vccz seen_105
    s_cmp_lt_u32 s74, 131072
    s_cbranch_scc1 poll_104
seen_105:
    s_add_u32 s75, s7, 0
    buffer_load_dwordx4 v[24:27], v6, s[64:67], s75 offen offset:0 sc1
    buffer_load_dwordx4 v[28:31], v6, s[64:67], s75 offen offset:1024 sc1
    buffer_load_dwordx4 v[32:35], v6, s[64:67], s75 offen offset:2048 sc1
    buffer_load_dwordx4 v[36:39], v6, s[64:67], s75 offen offset:3072 sc1
    buffer_load_dwordx4 v[40:43], v7, s[64:67], s75 offen offset:0 sc1
    buffer_load_dwordx4 v[44:47], v7, s[64:67], s75 offen offset:1024 sc1
    buffer_load_dwordx4 v[48:51], v7, s[64:67], s75 offen offset:2048 sc1
    s_add_u32 s75, s6, 0
    buffer_load_dwordx4 v[52:55], v6, s[64:67], s75 offen offset:0 sc1
    s_waitcnt vmcnt(7)
    v_mfma_f32_16x16x32_bf16 v[104:107], v[144:147], v[24:27], 0
    buffer_load_dwordx4 v[56:59], v6, s[64:67], s75 offen offset:1024 sc1
    v_mfma_f32_16x16x32_bf16 v[108:111], v[148:151], v[24:27], 0
    v_mfma_f32_16x16x32_bf16 v[112:115], v[152:155], v[24:27], 0
    buffer_load_dwordx4 v[60:63], v6, s[64:67], s75 offen offset:2048 sc1
    v_mfma_f32_16x16x32_bf16 v[116:119], v[156:159], v[24:27], 0
    buffer_load_dword v2, v15, s[64:67], s10 offen offset:128 sc1
    s_waitcnt vmcnt(8)
    v_mfma_f32_16x16x32_bf16 v[104:107], v[160:163], v[28:31], v[104:107]
    buffer_load_dwordx4 v[24:27], v6, s[64:67], s75 offen offset:3072 sc1
    v_mfma_f32_16x16x32_bf16 v[104:107], v[176:179], v[32:35], v[104:107]
    v_mfma_f32_16x16x32_bf16 v[108:111], v[180:183], v[32:35], v[108:111]
    v_mfma_f32_16x16x32_bf16 v[108:111], v[164:167], v[28:31], v[108:111]
    s_waitcnt vmcnt(9)
    v_mfma_f32_16x16x32_bf16 v[112:115], v[168:171], v[28:31], v[112:115]
    v_mfma_f32_16x16x32_bf16 v[112:115], v[184:187], v[32:35], v[112:115]
    v_mfma_f32_16x16x32_bf16 v[116:119], v[188:191], v[32:35], v[116:119]
    v_mfma_f32_16x16x32_bf16 v[116:119], v[172:175], v[28:31], v[116:119]
    s_waitcnt vmcnt(7)
    v_mfma_f32_16x16x32_bf16 v[104:107], v[192:195], v[36:39], v[104:107]
    buffer_load_dwordx4 v[28:31], v7, s[64:67], s75 offen offset:0 sc1
    v_mfma_f32_16x16x32_bf16 v[104:107], v[208:211], v[40:43], v[104:107]
    v_mfma_f32_16x16x32_bf16 v[108:111], v[212:215], v[40:43], v[108:111]
    buffer_load_dwordx4 v[32:35], v7, s[64:67], s75 offen offset:1024 sc1
    v_mfma_f32_16x16x32_bf16 v[108:111], v[196:199], v[36:39], v[108:111]
    s_waitcnt vmcnt(9)
    v_mfma_f32_16x16x32_bf16 v[112:115], v[200:203], v[36:39], v[112:115]
    v_mfma_f32_16x16x32_bf16 v[112:115], v[216:219], v[40:43], v[112:115]
    v_mfma_f32_16x16x32_bf16 v[116:119], v[220:223], v[40:43], v[116:119]
    v_mfma_f32_16x16x32_bf16 v[116:119], v[204:207], v[36:39], v[116:119]
    s_waitcnt vmcnt(7)
    v_mfma_f32_16x16x32_bf16 v[104:107], v[224:227], v[44:47], v[104:107]
    buffer_load_dwordx4 v[36:39], v7, s[64:67], s75 offen offset:2048 sc1
    v_mfma_f32_16x16x32_bf16 v[104:107], v[240:243], v[48:51], v[104:107]
    v_mfma_f32_16x16x32_bf16 v[108:111], v[244:247], v[48:51], v[108:111]
    v_mfma_f32_16x16x32_bf16 v[108:111], v[228:231], v[44:47], v[108:111]
    s_waitcnt vmcnt(8)
    v_mfma_f32_16x16x32_bf16 v[112:115], v[232:235], v[44:47], v[112:115]
    v_mfma_f32_16x16x32_bf16 v[112:115], v[248:251], v[48:51], v[112:115]
    v_mfma_f32_16x16x32_bf16 v[116:119], v[252:255], v[48:51], v[116:119]
    v_mfma_f32_16x16x32_bf16 v[116:119], v[236:239], v[44:47], v[116:119]
    s_waitcnt lgkmcnt(0)
    s_waitcnt vmcnt(4)
    s_mov_b32 s74, 0
again_106:
    v_cmp_ne_u32 vcc, s38, v2
    s_cbranch_vccz got_107
    s_add_u32 s74, s74, 1
    s_cmp_ge_u32 s74, 131072
    s_cbranch_scc1 got_107
    buffer_load_dword v2, v15, s[64:67], s10 offen offset:128 sc1
    s_waitcnt vmcnt(0)
    s_branch again_106
got_107:
    buffer_load_dword v3, v15, s[64:67], s9 offen offset:0 sc1
    s_waitcnt vmcnt(8)
    v_mfma_f32_16x16x32_bf16 v[120:123], v[144:147], v[52:55], 0
    s_add_u32 s75, s7, 57344
    buffer_load_dwordx4 v[40:43], v6, s[64:67], s75 offen offset:0 sc1
    v_mfma_f32_16x16x32_bf16 v[124:127], v[148:151], v[52:55], 0
    v_mfma_f32_16x16x32_bf16 v[128:131], v[152:155], v[52:55], 0
    buffer_load_dwordx4 v[44:47], v6, s[64:67], s75 offen offset:1024 sc1
    v_mfma_f32_16x16x32_bf16 v[132:135], v[156:159], v[52:55], 0
    s_waitcnt vmcnt(8)
    v_mfma_f32_16x16x32_bf16 v[120:123], v[160:163], v[56:59], v[120:123]
    buffer_load_dwordx4 v[48:51], v6, s[64:67], s75 offen offset:2048 sc1
    v_mfma_f32_16x16x32_bf16 v[120:123], v[176:179], v[60:63], v[120:123]
    v_mfma_f32_16x16x32_bf16 v[124:127], v[180:183], v[60:63], v[124:127]
    buffer_load_dwordx4 v[52:55], v6, s[64:67], s75 offen offset:3072 sc1
    v_mfma_f32_16x16x32_bf16 v[124:127], v[164:167], v[56:59], v[124:127]
    ds_write_b128 v10, v[104:107] offset:0
    s_waitcnt vmcnt(10)
    v_mfma_f32_16x16x32_bf16 v[128:131], v[168:171], v[56:59], v[128:131]
    v_mfma_f32_16x16x32_bf16 v[128:131], v[184:187], v[60:63], v[128:131]
    v_mfma_f32_16x16x32_bf16 v[132:135], v[188:191], v[60:63], v[132:135]
    v_mfma_f32_16x16x32_bf16 v[132:135], v[172:175], v[56:59], v[132:135]
    ds_write_b128 v11, v[108:111] offset:1024
    s_waitcnt vmcnt(7)
    v_mfma_f32_16x16x32_bf16 v[120:123], v[192:195], v[24:27], v[120:123]
    buffer_load_dwordx4 v[56:59], v7, s[64:67], s75 offen offset:0 sc1
    v_mfma_f32_16x16x32_bf16 v[120:123], v[208:211], v[28:31], v[120:123]
    v_mfma_f32_16x16x32_bf16 v[124:127], v[212:215], v[28:31], v[124:127]
    buffer_load_dwordx4 v[60:63], v7, s[64:67], s75 offen offset:1024 sc1
    v_mfma_f32_16x16x32_bf16 v[124:127], v[196:199], v[24:27], v[124:127]
    ds_write_b128 v12, v[112:115] offset:2048
    s_waitcnt vmcnt(9)
    v_mfma_f32_16x16x32_bf16 v[128:131], v[200:203], v[24:27], v[128:131]
    v_mfma_f32_16x16x32_bf16 v[128:131], v[216:219], v[28:31], v[128:131]
    v_mfma_f32_16x16x32_bf16 v[132:135], v[220:223], v[28:31], v[132:135]
    v_mfma_f32_16x16x32_bf16 v[132:135], v[204:207], v[24:27], v[132:135]
    ds_write_b128 v13, v[116:119] offset:3072
    ds_write_b32 v14, v5 offset:0
    s_waitcnt vmcnt(7)
    v_mfma_f32_16x16x32_bf16 v[120:123], v[224:227], v[32:35], v[120:123]
    buffer_load_dwordx4 v[24:27], v7, s[64:67], s75 offen offset:2048 sc1
    v_mfma_f32_16x16x32_bf16 v[120:123], v[240:243], v[36:39], v[120:123]
    v_mfma_f32_16x16x32_bf16 v[124:127], v[244:247], v[36:39], v[124:127]
    v_mfma_f32_16x16x32_bf16 v[124:127], v[228:231], v[32:35], v[124:127]
    s_waitcnt vmcnt(8)
    v_mfma_f32_16x16x32_bf16 v[128:131], v[232:235], v[32:35], v[128:131]
    v_mfma_f32_16x16x32_bf16 v[128:131], v[248:251], v[36:39], v[128:131]
    v_mfma_f32_16x16x32_bf16 v[132:135], v[252:255], v[36:39], v[132:135]
    v_mfma_f32_16x16x32_bf16 v[132:135], v[236:239], v[32:35], v[132:135]
    s_waitcnt lgkmcnt(0)
    s_waitcnt vmcnt(7)
    s_mov_b32 s74, 0
again_108:
    v_cmp_ne_u32 vcc, s38, v3
    s_cbranch_vccz got_109
    s_add_u32 s74, s74, 1
    s_cmp_ge_u32 s74, 131072
    s_cbranch_scc1 got_109
    buffer_load_dword v3, v15, s[64:67], s9 offen offset:0 sc1
    s_waitcnt vmcnt(0)
    s_branch again_108
got_109:
    buffer_load_dword v4, v15, s[64:67], s9 offen offset:128 sc1
    s_waitcnt vmcnt(7)
    v_mfma_f32_16x16x32_bf16 v[104:107], v[144:147], v[40:43], 0
    s_add_u32 s75, s7, 458752
    buffer_load_dwordx4 v[28:31], v6, s[64:67], s75 offen offset:0 sc1
    v_mfma_f32_16x16x32_bf16 v[108:111], v[148:151], v[40:43], 0
    v_mfma_f32_16x16x32_bf16 v[112:115], v[152:155], v[40:43], 0
    buffer_load_dwordx4 v[32:35], v6, s[64:67], s75 offen offset:1024 sc1
    v_mfma_f32_16x16x32_bf16 v[116:119], v[156:159], v[40:43], 0
    s_waitcnt vmcnt(7)
    v_mfma_f32_16x16x32_bf16 v[104:107], v[160:163], v[44:47], v[104:107]
    buffer_load_dwordx4 v[36:39], v6, s[64:67], s75 offen offset:2048 sc1
    v_mfma_f32_16x16x32_bf16 v[104:107], v[176:179], v[48:51], v[104:107]
    v_mfma_f32_16x16x32_bf16 v[108:111], v[180:183], v[48:51], v[108:111]
    buffer_load_dwordx4 v[40:43], v6, s[64:67], s75 offen offset:3072 sc1
    v_mfma_f32_16x16x32_bf16 v[108:111], v[164:167], v[44:47], v[108:111]
    ds_write_b128 v10, v[120:123] offset:16384
    s_waitcnt vmcnt(9)
    v_mfma_f32_16x16x32_bf16 v[112:115], v[168:171], v[44:47], v[112:115]
    v_mfma_f32_16x16x32_bf16 v[112:115], v[184:187], v[48:51], v[112:115]
    v_mfma_f32_16x16x32_bf16 v[116:119], v[188:191], v[48:51], v[116:119]
    v_mfma_f32_16x16x32_bf16 v[116:119], v[172:175], v[44:47], v[116:119]
    ds_write_b128 v11, v[124:127] offset:17408
    s_waitcnt vmcnt(7)
    v_mfma_f32_16x16x32_bf16 v[104:107], v[192:195], v[52:55], v[104:107]
    buffer_load_dwordx4 v[44:47], v7, s[64:67], s75 offen offset:0 sc1
    v_mfma_f32_16x16x32_bf16 v[104:107], v[208:211], v[56:59], v[104:107]
    v_mfma_f32_16x16x32_bf16 v[108:111], v[212:215], v[56:59], v[108:111]
    buffer_load_dwordx4 v[48:51], v7, s[64:67], s75 offen offset:1024 sc1
    v_mfma_f32_16x16x32_bf16 v[108:111], v[196:199], v[52:55], v[108:111]
    ds_write_b128 v12, v[128:131] offset:18432
    s_waitcnt vmcnt(9)
    v_mfma_f32_16x16x32_bf16 v[112:115], v[200:203], v[52:55], v[112:115]
    v_mfma_f32_16x16x32_bf16 v[112:115], v[216:219], v[56:59], v[112:115]
    v_mfma_f32_16x16x32_bf16 v[116:119], v[220:223], v[56:59], v[116:119]
    v_mfma_f32_16x16x32_bf16 v[116:119], v[204:207], v[52:55], v[116:119]
    ds_write_b128 v13, v[132:135] offset:19456
    ds_write_b32 v14, v5 offset:32
    s_waitcnt vmcnt(7)
    v_mfma_f32_16x16x32_bf16 v[104:107], v[224:227], v[60:63], v[104:107]
    buffer_load_dwordx4 v[52:55], v7, s[64:67], s75 offen offset:2048 sc1
    v_mfma_f32_16x16x32_bf16 v[104:107], v[240:243], v[24:27], v[104:107]
    v_mfma_f32_16x16x32_bf16 v[108:111], v[244:247], v[24:27], v[108:111]
    v_mfma_f32_16x16x32_bf16 v[108:111], v[228:231], v[60:63], v[108:111]
    s_waitcnt vmcnt(8)
    v_mfma_f32_16x16x32_bf16 v[112:115], v[232:235], v[60:63], v[112:115]
    v_mfma_f32_16x16x32_bf16 v[112:115], v[248:251], v[24:27], v[112:115]
    v_mfma_f32_16x16x32_bf16 v[116:119], v[252:255], v[24:27], v[116:119]
    v_mfma_f32_16x16x32_bf16 v[116:119], v[236:239], v[60:63], v[116:119]
    s_waitcnt lgkmcnt(0)
    s_waitcnt vmcnt(7)
    s_mov_b32 s74, 0
again_110:
    v_cmp_ne_u32 vcc, s38, v4
    s_cbranch_vccz got_111
    s_add_u32 s74, s74, 1
    s_cmp_ge_u32 s74, 131072
    s_cbranch_scc1 got_111
    buffer_load_dword v4, v15, s[64:67], s9 offen offset:128 sc1
    s_waitcnt vmcnt(0)
    s_branch again_110
got_111:
    s_waitcnt vmcnt(6)
    v_mfma_f32_16x16x32_bf16 v[120:123], v[144:147], v[28:31], 0
    s_add_u32 s75, s7, 516096
    buffer_load_dwordx4 v[56:59], v6, s[64:67], s75 offen offset:0 sc1
    v_mfma_f32_16x16x32_bf16 v[124:127], v[148:151], v[28:31], 0
    v_mfma_f32_16x16x32_bf16 v[128:131], v[152:155], v[28:31], 0
    buffer_load_dwordx4 v[60:63], v6, s[64:67], s75 offen offset:1024 sc1
    v_mfma_f32_16x16x32_bf16 v[132:135], v[156:159], v[28:31], 0
    s_waitcnt vmcnt(6)
    v_mfma_f32_16x16x32_bf16 v[120:123], v[160:163], v[32:35], v[120:123]
    buffer_load_dwordx4 v[24:27], v6, s[64:67], s75 offen offset:2048 sc1
    v_mfma_f32_16x16x32_bf16 v[120:123], v[176:179], v[36:39], v[120:123]
    v_mfma_f32_16x16x32_bf16 v[124:127], v[180:183], v[36:39], v[124:127]
    buffer_load_dwordx4 v[28:31], v6, s[64:67], s75 offen offset:3072 sc1
    v_mfma_f32_16x16x32_bf16 v[124:127], v[164:167], v[32:35], v[124:127]
    ds_write_b128 v10, v[104:107] offset:32768
    s_waitcnt vmcnt(8)
    v_mfma_f32_16x16x32_bf16 v[128:131], v[168:171], v[32:35], v[128:131]
    v_mfma_f32_16x16x32_bf16 v[128:131], v[184:187], v[36:39], v[128:131]
    v_mfma_f32_16x16x32_bf16 v[132:135], v[188:191], v[36:39], v[132:135]
    v_mfma_f32_16x16x32_bf16 v[132:135], v[172:175], v[32:35], v[132:135]
    ds_write_b128 v11, v[108:111] offset:33792
    s_waitcnt vmcnt(6)
    v_mfma_f32_16x16x32_bf16 v[120:123], v[192:195], v[40:43], v[120:123]
    buffer_load_dwordx4 v[32:35], v7, s[64:67], s75 offen offset:0 sc1
    v_mfma_f32_16x16x32_bf16 v[120:123], v[208:211], v[44:47], v[120:123]
    v_mfma_f32_16x16x32_bf16 v[124:127], v[212:215], v[44:47], v[124:127]
    buffer_load_dwordx4 v[36:39], v7, s[64:67], s75 offen offset:1024 sc1
    v_mfma_f32_16x16x32_bf16 v[124:127], v[196:199], v[40:43], v[124:127]
    ds_write_b128 v12, v[112:115] offset:34816
    s_waitcnt vmcnt(8)
    v_mfma_f32_16x16x32_bf16 v[128:131], v[200:203], v[40:43], v[128:131]
    v_mfma_f32_16x16x32_bf16 v[128:131], v[216:219], v[44:47], v[128:131]
    v_mfma_f32_16x16x32_bf16 v[132:135], v[220:223], v[44:47], v[132:135]
    v_mfma_f32_16x16x32_bf16 v[132:135], v[204:207], v[40:43], v[132:135]
    ds_write_b128 v13, v[116:119] offset:35840
    ds_write_b32 v14, v5 offset:64
    s_waitcnt vmcnt(6)
    v_mfma_f32_16x16x32_bf16 v[120:123], v[224:227], v[48:51], v[120:123]
    buffer_load_dwordx4 v[40:43], v7, s[64:67], s75 offen offset:2048 sc1
    v_mfma_f32_16x16x32_bf16 v[120:123], v[240:243], v[52:55], v[120:123]
    v_mfma_f32_16x16x32_bf16 v[124:127], v[244:247], v[52:55], v[124:127]
    s_add_u32 s75, s6, s48
    buffer_load_dwordx4 v[44:47], v6, s[64:67], s75 offen offset:0 sc1
    v_mfma_f32_16x16x32_bf16 v[124:127], v[228:231], v[48:51], v[124:127]
    s_waitcnt vmcnt(8)
    v_mfma_f32_16x16x32_bf16 v[128:131], v[232:235], v[48:51], v[128:131]
    v_mfma_f32_16x16x32_bf16 v[128:131], v[248:251], v[52:55], v[128:131]
    v_mfma_f32_16x16x32_bf16 v[132:135], v[252:255], v[52:55], v[132:135]
    v_mfma_f32_16x16x32_bf16 v[132:135], v[236:239], v[48:51], v[132:135]
    s_waitcnt lgkmcnt(0)
    s_waitcnt vmcnt(7)
    v_mfma_f32_16x16x32_bf16 v[104:107], v[144:147], v[56:59], 0
    buffer_load_dwordx4 v[48:51], v6, s[64:67], s75 offen offset:1024 sc1
    v_mfma_f32_16x16x32_bf16 v[108:111], v[148:151], v[56:59], 0
    v_mfma_f32_16x16x32_bf16 v[112:115], v[152:155], v[56:59], 0
    buffer_load_dwordx4 v[52:55], v6, s[64:67], s75 offen offset:2048 sc1
    v_mfma_f32_16x16x32_bf16 v[116:119], v[156:159], v[56:59], 0
    s_waitcnt vmcnt(7)
    v_mfma_f32_16x16x32_bf16 v[104:107], v[160:163], v[60:63], v[104:107]
    buffer_load_dwordx4 v[56:59], v6, s[64:67], s75 offen offset:3072 sc1
    v_mfma_f32_16x16x32_bf16 v[104:107], v[176:179], v[24:27], v[104:107]
    v_mfma_f32_16x16x32_bf16 v[108:111], v[180:183], v[24:27], v[108:111]
    v_mfma_f32_16x16x32_bf16 v[108:111], v[164:167], v[60:63], v[108:111]
    v_add_u32 v10, 65536, v10
    v_add_u32 v11, 65536, v11
    v_add_u32 v12, 65536, v12
    v_add_u32 v13, 65536, v13
    ds_write_b128 v10, v[120:123] offset:0
    s_waitcnt vmcnt(8)
    v_mfma_f32_16x16x32_bf16 v[112:115], v[168:171], v[60:63], v[112:115]
    v_mfma_f32_16x16x32_bf16 v[112:115], v[184:187], v[24:27], v[112:115]
    v_mfma_f32_16x16x32_bf16 v[116:119], v[188:191], v[24:27], v[116:119]
    v_mfma_f32_16x16x32_bf16 v[116:119], v[172:175], v[60:63], v[116:119]
    ds_write_b128 v11, v[124:127] offset:1024
    s_waitcnt vmcnt(6)
    v_mfma_f32_16x16x32_bf16 v[104:107], v[192:195], v[28:31], v[104:107]
    buffer_load_dwordx4 v[60:63], v7, s[64:67], s75 offen offset:0 sc1
    v_mfma_f32_16x16x32_bf16 v[104:107], v[208:211], v[32:35], v[104:107]
    v_mfma_f32_16x16x32_bf16 v[108:111], v[212:215], v[32:35], v[108:111]
    buffer_load_dwordx4 v[24:27], v7, s[64:67], s75 offen offset:1024 sc1
    v_mfma_f32_16x16x32_bf16 v[108:111], v[196:199], v[28:31], v[108:111]
    ds_write_b128 v12, v[128:131] offset:2048
    s_waitcnt vmcnt(8)
    v_mfma_f32_16x16x32_bf16 v[112:115], v[200:203], v[28:31], v[112:115]
    v_mfma_f32_16x16x32_bf16 v[112:115], v[216:219], v[32:35], v[112:115]
    v_mfma_f32_16x16x32_bf16 v[116:119], v[220:223], v[32:35], v[116:119]
    v_mfma_f32_16x16x32_bf16 v[116:119], v[204:207], v[28:31], v[116:119]
    ds_write_b128 v13, v[132:135] offset:3072
    ds_write_b32 v14, v5 offset:96
    s_waitcnt vmcnt(6)
    v_mfma_f32_16x16x32_bf16 v[104:107], v[224:227], v[36:39], v[104:107]
    buffer_load_dwordx4 v[28:31], v7, s[64:67], s75 offen offset:2048 sc1
    v_mfma_f32_16x16x32_bf16 v[104:107], v[240:243], v[40:43], v[104:107]
    v_mfma_f32_16x16x32_bf16 v[108:111], v[244:247], v[40:43], v[108:111]
    s_add_u32 s75, s6, s49
    buffer_load_dwordx4 v[32:35], v6, s[64:67], s75 offen offset:0 sc1
    v_mfma_f32_16x16x32_bf16 v[108:111], v[228:231], v[36:39], v[108:111]
    s_waitcnt vmcnt(8)
    v_mfma_f32_16x16x32_bf16 v[112:115], v[232:235], v[36:39], v[112:115]
    v_mfma_f32_16x16x32_bf16 v[112:115], v[248:251], v[40:43], v[112:115]
    v_mfma_f32_16x16x32_bf16 v[116:119], v[252:255], v[40:43], v[116:119]
    v_mfma_f32_16x16x32_bf16 v[116:119], v[236:239], v[36:39], v[116:119]
    s_waitcnt lgkmcnt(0)
    s_waitcnt vmcnt(7)
    v_mfma_f32_16x16x32_bf16 v[120:123], v[144:147], v[44:47], 0
    buffer_load_dwordx4 v[36:39], v6, s[64:67], s75 offen offset:1024 sc1
    v_mfma_f32_16x16x32_bf16 v[124:127], v[148:151], v[44:47], 0
    v_mfma_f32_16x16x32_bf16 v[128:131], v[152:155], v[44:47], 0
    buffer_load_dwordx4 v[40:43], v6, s[64:67], s75 offen offset:2048 sc1
    v_mfma_f32_16x16x32_bf16 v[132:135], v[156:159], v[44:47], 0
    s_waitcnt vmcnt(7)
    v_mfma_f32_16x16x32_bf16 v[120:123], v[160:163], v[48:51], v[120:123]
    buffer_load_dwordx4 v[44:47], v6, s[64:67], s75 offen offset:3072 sc1
    v_mfma_f32_16x16x32_bf16 v[120:123], v[176:179], v[52:55], v[120:123]
    v_mfma_f32_16x16x32_bf16 v[124:127], v[180:183], v[52:55], v[124:127]
    v_mfma_f32_16x16x32_bf16 v[124:127], v[164:167], v[48:51], v[124:127]
    ds_write_b128 v10, v[104:107] offset:16384
    s_waitcnt vmcnt(8)
    v_mfma_f32_16x16x32_bf16 v[128:131], v[168:171], v[48:51], v[128:131]
    v_mfma_f32_16x16x32_bf16 v[128:131], v[184:187], v[52:55], v[128:131]
    v_mfma_f32_16x16x32_bf16 v[132:135], v[188:191], v[52:55], v[132:135]
    v_mfma_f32_16x16x32_bf16 v[132:135], v[172:175], v[48:51], v[132:135]
    ds_write_b128 v11, v[108:111] offset:17408
    s_waitcnt vmcnt(6)
    v_mfma_f32_16x16x32_bf16 v[120:123], v[192:195], v[56:59], v[120:123]
    buffer_load_dwordx4 v[48:51], v7, s[64:67], s75 offen offset:0 sc1
    v_mfma_f32_16x16x32_bf16 v[120:123], v[208:211], v[60:63], v[120:123]
    v_mfma_f32_16x16x32_bf16 v[124:127], v[212:215], v[60:63], v[124:127]
    buffer_load_dwordx4 v[52:55], v7, s[64:67], s75 offen offset:1024 sc1
    v_mfma_f32_16x16x32_bf16 v[124:127], v[196:199], v[56:59], v[124:127]
    ds_write_b128 v12, v[112:115] offset:18432
    s_waitcnt vmcnt(8)
    v_mfma_f32_16x16x32_bf16 v[128:131], v[200:203], v[56:59], v[128:131]
    v_mfma_f32_16x16x32_bf16 v[128:131], v[216:219], v[60:63], v[128:131]
    v_mfma_f32_16x16x32_bf16 v[132:135], v[220:223], v[60:63], v[132:135]
    v_mfma_f32_16x16x32_bf16 v[132:135], v[204:207], v[56:59], v[132:135]
    ds_write_b128 v13, v[116:119] offset:19456
    ds_write_b32 v14, v5 offset:128
    s_waitcnt vmcnt(6)
    v_mfma_f32_16x16x32_bf16 v[120:123], v[224:227], v[24:27], v[120:123]
    buffer_load_dwordx4 v[56:59], v7, s[64:67], s75 offen offset:2048 sc1
    v_mfma_f32_16x16x32_bf16 v[120:123], v[240:243], v[28:31], v[120:123]
    v_mfma_f32_16x16x32_bf16 v[124:127], v[244:247], v[28:31], v[124:127]
    s_add_u32 s75, s6, s50
    buffer_load_dwordx4 v[60:63], v6, s[64:67], s75 offen offset:0 sc1
    v_mfma_f32_16x16x32_bf16 v[124:127], v[228:231], v[24:27], v[124:127]
    s_waitcnt vmcnt(8)
    v_mfma_f32_16x16x32_bf16 v[128:131], v[232:235], v[24:27], v[128:131]
    v_mfma_f32_16x16x32_bf16 v[128:131], v[248:251], v[28:31], v[128:131]
    v_mfma_f32_16x16x32_bf16 v[132:135], v[252:255], v[28:31], v[132:135]
    v_mfma_f32_16x16x32_bf16 v[132:135], v[236:239], v[24:27], v[132:135]
    s_waitcnt lgkmcnt(0)
    s_waitcnt vmcnt(7)
    v_mfma_f32_16x16x32_bf16 v[104:107], v[144:147], v[32:35], 0
    buffer_load_dwordx4 v[24:27], v6, s[64:67], s75 offen offset:1024 sc1
    v_mfma_f32_16x16x32_bf16 v[108:111], v[148:151], v[32:35], 0
    v_mfma_f32_16x16x32_bf16 v[112:115], v[152:155], v[32:35], 0
    buffer_load_dwordx4 v[28:31], v6, s[64:67], s75 offen offset:2048 sc1
    v_mfma_f32_16x16x32_bf16 v[116:119], v[156:159], v[32:35], 0
    s_waitcnt vmcnt(7)
    v_mfma_f32_16x16x32_bf16 v[104:107], v[160:163], v[36:39], v[104:107]
    buffer_load_dwordx4 v[32:35], v6, s[64:67], s75 offen offset:3072 sc1
    v_mfma_f32_16x16x32_bf16 v[104:107], v[176:179], v[40:43], v[104:107]
    v_mfma_f32_16x16x32_bf16 v[108:111], v[180:183], v[40:43], v[108:111]
    v_mfma_f32_16x16x32_bf16 v[108:111], v[164:167], v[36:39], v[108:111]
    ds_write_b128 v10, v[120:123] offset:32768
    s_waitcnt vmcnt(8)
    v_mfma_f32_16x16x32_bf16 v[112:115], v[168:171], v[36:39], v[112:115]
    v_mfma_f32_16x16x32_bf16 v[112:115], v[184:187], v[40:43], v[112:115]
    v_mfma_f32_16x16x32_bf16 v[116:119], v[188:191], v[40:43], v[116:119]
    v_mfma_f32_16x16x32_bf16 v[116:119], v[172:175], v[36:39], v[116:119]
    ds_write_b128 v11, v[124:127] offset:33792
    s_waitcnt vmcnt(6)
    v_mfma_f32_16x16x32_bf16 v[104:107], v[192:195], v[44:47], v[104:107]
    buffer_load_dwordx4 v[36:39], v7, s[64:67], s75 offen offset:0 sc1
    v_mfma_f32_16x16x32_bf16 v[104:107], v[208:211], v[48:51], v[104:107]
    v_mfma_f32_16x16x32_bf16 v[108:111], v[212:215], v[48:51], v[108:111]
    buffer_load_dwordx4 v[40:43], v7, s[64:67], s75 offen offset:1024 sc1
    v_mfma_f32_16x16x32_bf16 v[108:111], v[196:199], v[44:47], v[108:111]
    ds_write_b128 v12, v[128:131] offset:34816
    s_waitcnt vmcnt(8)
    v_mfma_f32_16x16x32_bf16 v[112:115], v[200:203], v[44:47], v[112:115]
    v_mfma_f32_16x16x32_bf16 v[112:115], v[216:219], v[48:51], v[112:115]
    v_mfma_f32_16x16x32_bf16 v[116:119], v[220:223], v[48:51], v[116:119]
    v_mfma_f32_16x16x32_bf16 v[116:119], v[204:207], v[44:47], v[116:119]
    ds_write_b128 v13, v[132:135] offset:35840
    ds_write_b32 v14, v5 offset:160
    s_waitcnt vmcnt(6)
    v_mfma_f32_16x16x32_bf16 v[104:107], v[224:227], v[52:55], v[104:107]
    buffer_load_dwordx4 v[44:47], v7, s[64:67], s75 offen offset:2048 sc1
    v_mfma_f32_16x16x32_bf16 v[104:107], v[240:243], v[56:59], v[104:107]
    v_mfma_f32_16x16x32_bf16 v[108:111], v[244:247], v[56:59], v[108:111]
    v_mfma_f32_16x16x32_bf16 v[108:111], v[228:231], v[52:55], v[108:111]
    s_waitcnt vmcnt(7)
    v_mfma_f32_16x16x32_bf16 v[112:115], v[232:235], v[52:55], v[112:115]
    v_mfma_f32_16x16x32_bf16 v[112:115], v[248:251], v[56:59], v[112:115]
    v_mfma_f32_16x16x32_bf16 v[116:119], v[252:255], v[56:59], v[116:119]
    v_mfma_f32_16x16x32_bf16 v[116:119], v[236:239], v[52:55], v[116:119]
    s_waitcnt lgkmcnt(0)
    s_waitcnt vmcnt(6)
    v_mfma_f32_16x16x32_bf16 v[120:123], v[144:147], v[60:63], 0
    v_mfma_f32_16x16x32_bf16 v[124:127], v[148:151], v[60:63], 0
    v_mfma_f32_16x16x32_bf16 v[128:131], v[152:155], v[60:63], 0
    v_mfma_f32_16x16x32_bf16 v[132:135], v[156:159], v[60:63], 0
    s_waitcnt vmcnt(4)
    v_mfma_f32_16x16x32_bf16 v[120:123], v[160:163], v[24:27], v[120:123]
    v_mfma_f32_16x16x32_bf16 v[120:123], v[176:179], v[28:31], v[120:123]
    v_mfma_f32_16x16x32_bf16 v[124:127], v[180:183], v[28:31], v[124:127]
    v_mfma_f32_16x16x32_bf16 v[124:127], v[164:167], v[24:27], v[124:127]
    ds_write_b128 v10, v[104:107] offset:49152
    s_waitcnt vmcnt(4)
    v_mfma_f32_16x16x32_bf16 v[128:131], v[168:171], v[24:27], v[128:131]
    v_mfma_f32_16x16x32_bf16 v[128:131], v[184:187], v[28:31], v[128:131]
    v_mfma_f32_16x16x32_bf16 v[132:135], v[188:191], v[28:31], v[132:135]
    v_mfma_f32_16x16x32_bf16 v[132:135], v[172:175], v[24:27], v[132:135]
    ds_write_b128 v11, v[108:111] offset:50176
    s_waitcnt vmcnt(2)
    v_mfma_f32_16x16x32_bf16 v[120:123], v[192:195], v[32:35], v[120:123]
    v_mfma_f32_16x16x32_bf16 v[120:123], v[208:211], v[36:39], v[120:123]
    v_mfma_f32_16x16x32_bf16 v[124:127], v[212:215], v[36:39], v[124:127]
    v_mfma_f32_16x16x32_bf16 v[124:127], v[196:199], v[32:35], v[124:127]
    ds_write_b128 v12, v[112:115] offset:51200
    s_waitcnt vmcnt(2)
    v_mfma_f32_16x16x32_bf16 v[128:131], v[200:203], v[32:35], v[128:131]
    v_mfma_f32_16x16x32_bf16 v[128:131], v[216:219], v[36:39], v[128:131]
    v_mfma_f32_16x16x32_bf16 v[132:135], v[220:223], v[36:39], v[132:135]
    v_mfma_f32_16x16x32_bf16 v[132:135], v[204:207], v[32:35], v[132:135]
    ds_write_b128 v13, v[116:119] offset:52224
    ds_write_b32 v14, v5 offset:192
    s_waitcnt vmcnt(0)
    v_mfma_f32_16x16x32_bf16 v[120:123], v[224:227], v[40:43], v[120:123]
    v_mfma_f32_16x16x32_bf16 v[120:123], v[240:243], v[44:47], v[120:123]
    v_mfma_f32_16x16x32_bf16 v[124:127], v[244:247], v[44:47], v[124:127]
    v_mfma_f32_16x16x32_bf16 v[124:127], v[228:231], v[40:43], v[124:127]
    s_waitcnt vmcnt(0)
    v_mfma_f32_16x16x32_bf16 v[128:131], v[232:235], v[40:43], v[128:131]
    v_mfma_f32_16x16x32_bf16 v[128:131], v[248:251], v[44:47], v[128:131]
    v_mfma_f32_16x16x32_bf16 v[132:135], v[252:255], v[44:47], v[132:135]
    v_mfma_f32_16x16x32_bf16 v[132:135], v[236:239], v[40:43], v[132:135]
    s_waitcnt lgkmcnt(0)
    v_add_u32 v10, 65536, v10
    v_add_u32 v11, 65536, v11
    v_add_u32 v12, 65536, v12
    v_add_u32 v13, 65536, v13
    ds_write_b128 v10, v[120:123] offset:0
    ds_write_b128 v11, v[124:127] offset:1024
    ds_write_b128 v12, v[128:131] offset:2048
    ds_write_b128 v13, v[132:135] offset:3072
    ds_write_b32 v14, v5 offset:224
L_done:
    s_endpgm
L_exit:
L_last:
    s_endpgm
.section .rodata,"a"
.p2align 6
.amdhsa_kernel adaLN_cond__ssm_conv_h3__glu_gated_geglu__prompt_kernel
  .amdhsa_next_free_vgpr 256
  .amdhsa_next_free_sgpr 102
  .amdhsa_accum_offset 256
  .amdhsa_group_segment_fixed_size 0
  .amdhsa_kernarg_size 120
  .amdhsa_user_sgpr_count 2
  .amdhsa_user_sgpr_kernarg_segment_ptr 1
  .amdhsa_system_sgpr_workgroup_id_x 1
  .amdhsa_float_denorm_mode_32 3
.end_amdhsa_kernel
```
